```python
import torch

def _softmax(x, axis=-1):
    return torch.softmax(x, dim=axis)
def _gelu(x):
    return torch.nn.functional.gelu(x, approximate="tanh")
def _silu(x):
    return torch.nn.functional.silu(x)
def _sigmoid(x):
    return torch.sigmoid(x)
def _layernorm(x, axis=-1, eps=1e-5):
    m = x.mean(dim=axis, keepdim=True)
    v = x.var(dim=axis, keepdim=True, unbiased=False)
    return (x - m) / torch.sqrt(v + eps)
def _scatter_add(tgt, idx, src, axis=0):
    return tgt.clone().index_add_(axis, idx, src)
def _segment_sum(src, seg, n):
    out = torch.zeros((n,) + src.shape[1:], dtype=src.dtype)
    return out.index_add_(0, seg, src)
def _pad(x, pw):
    flat = tuple(v for pair in reversed(pw) for v in pair)
    return torch.nn.functional.pad(x, flat)

kernel_name = 'parallel_sum__ssm_conv_s4d__mixer_token_mlp__prompt'

def setup_inputs():

    _w = (lambda a: (lambda t: t.to(torch.bfloat16) if t.is_floating_point() else t)(torch.as_tensor(a)))
    def _A_setup():
        Bsz, L, D, N = 1, 2048, 512, 128
        return {
            "u": _w((lambda *s: torch.randn(*s, dtype=torch.bfloat16) * 0.05)(Bsz, L, D)),
            "log_A_real": _w((lambda *s: torch.randn(*s, dtype=torch.bfloat16) * 3.2)(D, N) * 0.5),
            "A_imag": _w((lambda *s: torch.randn(*s, dtype=torch.bfloat16) * 0.05)(D, N) * 3.14),
            "C_real": _w((lambda *s: torch.randn(*s, dtype=torch.bfloat16) * 0.2)(D, N) / N ** 0.5),
            "C_imag": _w((lambda *s: torch.randn(*s, dtype=torch.bfloat16) * 0.4)(D, N) / N ** 0.5),
            "log_dt": _w((lambda *s: torch.randn(*s, dtype=torch.bfloat16) * 0.05)(D) * 0.5 - 4.0),
            "D_skip": _w((lambda *s: torch.randn(*s, dtype=torch.bfloat16) * 0.05)(D)),
        }
    _A_in = _A_setup()

    def _B_setup():
        B, S, D, F = 1, 2048, 512, 1792
        return {
            "x": _w((lambda *s: torch.randn(*s, dtype=torch.bfloat16) * 0.05)(B, S, D)),
            "w1": _w((lambda *s: torch.randn(*s, dtype=torch.bfloat16) * 0.8)(S, F) * (S ** -0.5)),
            "b1": _w((lambda *s: torch.randn(*s, dtype=torch.bfloat16) * 3.2)(F) * 0.02),
            "w2": _w((lambda *s: torch.randn(*s, dtype=torch.bfloat16) * 0.8)(F, S) * (F ** -0.5)),
            "b2": _w((lambda *s: torch.randn(*s, dtype=torch.bfloat16) * 3.2)(S) * 0.02),
        }
    _B_in = _B_setup()

    return {
        "A_u": _A_in["u"],
        "A_log_A_real": _A_in["log_A_real"],
        "A_A_imag": _A_in["A_imag"],
        "A_C_real": _A_in["C_real"],
        "A_C_imag": _A_in["C_imag"],
        "A_log_dt": _A_in["log_dt"],
        "A_D_skip": _A_in["D_skip"],
        "B_x": _B_in["x"],
        "B_w1": _B_in["w1"],
        "B_b1": _B_in["b1"],
        "B_w2": _B_in["w2"],
        "B_b2": _B_in["b2"],
    }

def reference(A_u, A_log_A_real, A_A_imag, A_C_real, A_C_imag, A_log_dt, A_D_skip, B_x, B_w1, B_b1, B_w2, B_b2):
    def _A_ref(u, log_A_real, A_imag, C_real, C_imag, log_dt, D_skip):
        L = u.shape[1]
        dt = torch.exp(log_dt)
        A = -torch.exp(log_A_real) + 1j * A_imag
        C = (C_real + 1j * C_imag) * dt[:, None]
        pos = (lambda x, dt: x.to(dt))(torch.arange(L), log_dt.dtype)
        P = torch.exp((A * dt[:, None])[:, :, None] * pos[None, None, :])
        K = 2.0 * torch.einsum("dn,dnl->dl", C, P).real
        L2 = 2 * L
        u_t = (lambda x, *d: x.permute(*d))(u, 0, 2, 1)
        Kf = (lambda x, *a, **k: torch.fft.rfft(x.float(), *a, **k))(K, L2)
        Uf = (lambda x, *a, **k: torch.fft.rfft(x.float(), *a, **k))(u_t, L2)
        y = (lambda x, *a, **k: torch.fft.irfft(x, *a, **k).to(torch.bfloat16))(Uf * Kf[None, :, :], L2)[:, :, :L]
        y = (lambda x, *d: x.permute(*d))(y, 0, 2, 1)
        return y + u * D_skip[None, None, :]

    def _B_ref(x, w1, b1, w2, b2):
        B, S, D = x.shape
        h = _layernorm(x, axis=-1)
        u = torch.einsum("bsd,sf->bdf", h, w1) + b1
        u = _gelu(u)
        y = torch.einsum("bdf,fs->bds", u, w2) + b2
        return (lambda x, *d: x.permute(*d))(y, 0, 2, 1)

    x = A_u
    xn = _layernorm(x, axis=-1)
    return x + _A_ref(xn, A_log_A_real, A_A_imag, A_C_real, A_C_imag, A_log_dt, A_D_skip) + _B_ref(xn, B_w1, B_b1, B_w2, B_b2)
```

```asm
; @launch kernel=k0_kernel grid=(320,1,1) block=(256,1,1) lds=24576
; @launch kernel=k1_kernel grid=(768,1,1) block=(256,1,1) lds=49152
; @launch kernel=k2_kernel grid=(256,1,1) block=(256,1,1) lds=65536
.amdgcn_target "amdgcn-amd-amdhsa--gfx950"
.text
.globl k0_kernel
.p2align 8
.type k0_kernel,@function
k0_kernel:
    s_load_dwordx2 s[4:5], s[0:1], 0
    s_load_dwordx2 s[6:7], s[0:1], 8
    s_load_dwordx2 s[8:9], s[0:1], 16
    s_load_dwordx2 s[10:11], s[0:1], 24
    s_load_dwordx2 s[12:13], s[0:1], 32
    s_load_dwordx2 s[14:15], s[0:1], 40
    s_load_dwordx2 s[16:17], s[0:1], 112
    v_lshrrev_b32 v1, 6, v0
    v_and_b32 v0, 63, v0
    v_readfirstlane_b32 s3, v1
    s_cmp_ge_u32 s2, 320
    s_cbranch_scc1 k0_end
    s_cmp_lt_u32 s2, 256
    s_cbranch_scc1 k0_ln
    s_sub_u32 s2, s2, 256
    s_cmp_lt_u32 s2, 64
    s_cbranch_scc1 k0_pf
k0_ln:
    s_waitcnt lgkmcnt(0)
    s_mov_b32 s20, s4
    s_and_b32 s21, s5, 0xffff
    s_mov_b32 s22, 0x200000
    s_mov_b32 s23, 0x00020000
    s_mov_b32 s24, s16
    s_and_b32 s25, s17, 0xffff
    s_mov_b32 s26, 0x200000
    s_mov_b32 s27, 0x00020000
    s_add_u32 s28, s16, 0x200000
    s_addc_u32 s29, s17, 0
    s_and_b32 s29, s29, 0xffff
    s_mov_b32 s30, 0x200000
    s_mov_b32 s31, 0x00020000
    s_add_u32 s32, s16, 0x400000
    s_addc_u32 s33, s17, 0
    s_and_b32 s33, s33, 0xffff
    s_mov_b32 s34, 0x200000
    s_mov_b32 s35, 0x00020000
    s_lshl_b32 s36, s2, 13
    s_lshl_b32 s37, s3, 11
    s_add_u32 s38, s36, s37
    v_lshlrev_b32 v2, 4, v0
    buffer_load_dwordx4 v[8:11], v2, s[20:23], s38 offen offset:0
    buffer_load_dwordx4 v[12:15], v2, s[20:23], s38 offen offset:1024
    v_mov_b32 v3, 0x3b000000
    v_mov_b32 v4, 0x3727c5ac
    v_add_u32 v5, s37, v2
    s_lshl_b32 s39, s3, 8
    v_lshlrev_b32 v6, 2, v0
    v_add_u32 v6, s39, v6
    v_lshlrev_b32 v7, 3, v6
    s_waitcnt vmcnt(0)
    ds_write_b128 v5, v[8:11] offset:0
    v_lshlrev_b32 v16, 16, v8
    v_and_b32 v17, 0xffff0000, v8
    v_lshlrev_b32 v18, 16, v9
    v_and_b32 v19, 0xffff0000, v9
    v_lshlrev_b32 v20, 16, v10
    v_and_b32 v21, 0xffff0000, v10
    v_lshlrev_b32 v22, 16, v11
    v_and_b32 v23, 0xffff0000, v11
    ds_write_b128 v5, v[12:15] offset:1024
    v_lshlrev_b32 v24, 16, v12
    v_and_b32 v25, 0xffff0000, v12
    v_lshlrev_b32 v26, 16, v13
    v_and_b32 v27, 0xffff0000, v13
    v_lshlrev_b32 v28, 16, v14
    v_and_b32 v29, 0xffff0000, v14
    v_lshlrev_b32 v30, 16, v15
    v_and_b32 v31, 0xffff0000, v15
    v_add_f32 v32, v16, v17
    v_add_f32 v40, v18, v19
    v_add_f32 v33, v24, v25
    v_add_f32 v41, v26, v27
    v_add_f32 v32, v32, v20
    v_add_f32 v40, v40, v21
    v_add_f32 v33, v33, v28
    v_add_f32 v41, v41, v29
    v_add_f32 v32, v32, v22
    v_add_f32 v40, v40, v23
    v_add_f32 v33, v33, v30
    v_add_f32 v41, v41, v31
    v_add_f32 v32, v32, v40
    v_add_f32 v33, v33, v41
    s_nop 0
    v_add_f32_dpp v32, v32, v32 quad_perm:[1,0,3,2] row_mask:0xf bank_mask:0xf
    v_add_f32_dpp v33, v33, v33 quad_perm:[1,0,3,2] row_mask:0xf bank_mask:0xf
    s_nop 0
    v_add_f32_dpp v32, v32, v32 quad_perm:[2,3,0,1] row_mask:0xf bank_mask:0xf
    v_add_f32_dpp v33, v33, v33 quad_perm:[2,3,0,1] row_mask:0xf bank_mask:0xf
    s_nop 0
    v_add_f32_dpp v32, v32, v32 row_half_mirror row_mask:0xf bank_mask:0xf
    v_add_f32_dpp v33, v33, v33 row_half_mirror row_mask:0xf bank_mask:0xf
    s_nop 0
    v_add_f32_dpp v32, v32, v32 row_mirror row_mask:0xf bank_mask:0xf
    v_add_f32_dpp v33, v33, v33 row_mirror row_mask:0xf bank_mask:0xf
    s_nop 0
    v_add_f32_dpp v32, v32, v32 row_bcast:15 row_mask:0xa bank_mask:0xf
    v_add_f32_dpp v33, v33, v33 row_bcast:15 row_mask:0xa bank_mask:0xf
    s_nop 0
    v_add_f32_dpp v32, v32, v32 row_bcast:31 row_mask:0xc bank_mask:0xf
    v_add_f32_dpp v33, v33, v33 row_bcast:31 row_mask:0xc bank_mask:0xf
    v_readlane_b32 s40, v32, 63
    v_readlane_b32 s41, v33, 63
    s_nop 0
    v_mul_f32 v34, s40, v3
    v_mul_f32 v35, s41, v3
    v_sub_f32 v40, v16, v34
    v_mul_f32 v32, v40, v40
    v_sub_f32 v42, v24, v35
    v_mul_f32 v33, v42, v42
    v_sub_f32 v41, v17, v34
    v_fmac_f32 v32, v41, v41
    v_sub_f32 v43, v25, v35
    v_fmac_f32 v33, v43, v43
    v_sub_f32 v40, v18, v34
    v_fmac_f32 v32, v40, v40
    v_sub_f32 v42, v26, v35
    v_fmac_f32 v33, v42, v42
    v_sub_f32 v41, v19, v34
    v_fmac_f32 v32, v41, v41
    v_sub_f32 v43, v27, v35
    v_fmac_f32 v33, v43, v43
    v_sub_f32 v40, v20, v34
    v_fmac_f32 v32, v40, v40
    v_sub_f32 v42, v28, v35
    v_fmac_f32 v33, v42, v42
    v_sub_f32 v41, v21, v34
    v_fmac_f32 v32, v41, v41
    v_sub_f32 v43, v29, v35
    v_fmac_f32 v33, v43, v43
    v_sub_f32 v40, v22, v34
    v_fmac_f32 v32, v40, v40
    v_sub_f32 v42, v30, v35
    v_fmac_f32 v33, v42, v42
    v_sub_f32 v41, v23, v34
    v_fmac_f32 v32, v41, v41
    v_sub_f32 v43, v31, v35
    v_fmac_f32 v33, v43, v43
    v_add_f32_dpp v32, v32, v32 quad_perm:[1,0,3,2] row_mask:0xf bank_mask:0xf
    s_nop 0
    v_add_f32_dpp v33, v33, v33 quad_perm:[1,0,3,2] row_mask:0xf bank_mask:0xf
    v_add_f32_dpp v32, v32, v32 quad_perm:[2,3,0,1] row_mask:0xf bank_mask:0xf
    s_nop 0
    v_add_f32_dpp v33, v33, v33 quad_perm:[2,3,0,1] row_mask:0xf bank_mask:0xf
    v_add_f32_dpp v32, v32, v32 row_half_mirror row_mask:0xf bank_mask:0xf
    s_nop 0
    v_add_f32_dpp v33, v33, v33 row_half_mirror row_mask:0xf bank_mask:0xf
    v_add_f32_dpp v32, v32, v32 row_mirror row_mask:0xf bank_mask:0xf
    s_nop 0
    v_add_f32_dpp v33, v33, v33 row_mirror row_mask:0xf bank_mask:0xf
    v_add_f32_dpp v32, v32, v32 row_bcast:15 row_mask:0xa bank_mask:0xf
    s_nop 0
    v_add_f32_dpp v33, v33, v33 row_bcast:15 row_mask:0xa bank_mask:0xf
    v_add_f32_dpp v32, v32, v32 row_bcast:31 row_mask:0xc bank_mask:0xf
    s_nop 0
    v_add_f32_dpp v33, v33, v33 row_bcast:31 row_mask:0xc bank_mask:0xf
    v_readlane_b32 s40, v32, 63
    v_readlane_b32 s41, v33, 63
    s_nop 0
    v_mul_f32 v36, s40, v3
    v_mul_f32 v37, s41, v3
    v_cvt_pk_bf16_f32 v38, v34, v35
    v_lshlrev_b32 v34, 16, v38
    v_and_b32 v35, 0xffff0000, v38
    v_cvt_pk_bf16_f32 v38, v36, v37
    v_lshlrev_b32 v36, 16, v38
    v_and_b32 v37, 0xffff0000, v38
    v_add_f32 v36, v36, v4
    v_add_f32 v37, v37, v4
    v_cvt_pk_bf16_f32 v38, v36, v37
    v_lshlrev_b32 v36, 16, v38
    v_and_b32 v37, 0xffff0000, v38
    v_sqrt_f32 v36, v36
    v_sqrt_f32 v37, v37
    s_nop 0
    v_cvt_pk_bf16_f32 v38, v36, v37
    v_lshlrev_b32 v36, 16, v38
    v_and_b32 v37, 0xffff0000, v38
    v_rcp_f32 v36, v36
    v_rcp_f32 v37, v37
    v_sub_f32 v40, v16, v34
    v_sub_f32 v41, v17, v34
    v_sub_f32 v42, v24, v35
    v_sub_f32 v43, v25, v35
    v_cvt_pk_bf16_f32 v38, v40, v41
    v_lshlrev_b32 v40, 16, v38
    v_and_b32 v41, 0xffff0000, v38
    v_cvt_pk_bf16_f32 v39, v42, v43
    v_lshlrev_b32 v42, 16, v39
    v_and_b32 v43, 0xffff0000, v39
    v_mul_f32 v40, v40, v36
    v_mul_f32 v41, v41, v36
    v_mul_f32 v42, v42, v37
    v_mul_f32 v43, v43, v37
    v_cvt_pk_bf16_f32 v44, v40, v41
    v_lshlrev_b32 v16, 16, v44
    v_and_b32 v17, 0xffff0000, v44
    v_cvt_pk_bf16_f32 v48, v42, v43
    v_lshlrev_b32 v24, 16, v48
    v_and_b32 v25, 0xffff0000, v48
    v_sub_f32 v40, v18, v34
    v_sub_f32 v41, v19, v34
    v_sub_f32 v42, v26, v35
    v_sub_f32 v43, v27, v35
    v_cvt_pk_bf16_f32 v38, v40, v41
    v_lshlrev_b32 v40, 16, v38
    v_and_b32 v41, 0xffff0000, v38
    v_cvt_pk_bf16_f32 v39, v42, v43
    v_lshlrev_b32 v42, 16, v39
    v_and_b32 v43, 0xffff0000, v39
    v_mul_f32 v40, v40, v36
    v_mul_f32 v41, v41, v36
    v_mul_f32 v42, v42, v37
    v_mul_f32 v43, v43, v37
    v_cvt_pk_bf16_f32 v45, v40, v41
    v_lshlrev_b32 v18, 16, v45
    v_and_b32 v19, 0xffff0000, v45
    v_cvt_pk_bf16_f32 v49, v42, v43
    v_lshlrev_b32 v26, 16, v49
    v_and_b32 v27, 0xffff0000, v49
    v_sub_f32 v40, v20, v34
    v_sub_f32 v41, v21, v34
    v_sub_f32 v42, v28, v35
    v_sub_f32 v43, v29, v35
    v_cvt_pk_bf16_f32 v38, v40, v41
    v_lshlrev_b32 v40, 16, v38
    v_and_b32 v41, 0xffff0000, v38
    v_cvt_pk_bf16_f32 v39, v42, v43
    v_lshlrev_b32 v42, 16, v39
    v_and_b32 v43, 0xffff0000, v39
    v_mul_f32 v40, v40, v36
    v_mul_f32 v41, v41, v36
    v_mul_f32 v42, v42, v37
    v_mul_f32 v43, v43, v37
    v_cvt_pk_bf16_f32 v46, v40, v41
    v_lshlrev_b32 v20, 16, v46
    v_and_b32 v21, 0xffff0000, v46
    v_cvt_pk_bf16_f32 v50, v42, v43
    v_lshlrev_b32 v28, 16, v50
    v_and_b32 v29, 0xffff0000, v50
    v_sub_f32 v40, v22, v34
    v_sub_f32 v41, v23, v34
    v_sub_f32 v42, v30, v35
    v_sub_f32 v43, v31, v35
    v_cvt_pk_bf16_f32 v38, v40, v41
    v_lshlrev_b32 v40, 16, v38
    v_and_b32 v41, 0xffff0000, v38
    v_cvt_pk_bf16_f32 v39, v42, v43
    v_lshlrev_b32 v42, 16, v39
    v_and_b32 v43, 0xffff0000, v39
    v_mul_f32 v40, v40, v36
    v_mul_f32 v41, v41, v36
    v_mul_f32 v42, v42, v37
    v_mul_f32 v43, v43, v37
    v_cvt_pk_bf16_f32 v47, v40, v41
    v_lshlrev_b32 v22, 16, v47
    v_and_b32 v23, 0xffff0000, v47
    v_cvt_pk_bf16_f32 v51, v42, v43
    v_lshlrev_b32 v30, 16, v51
    v_and_b32 v31, 0xffff0000, v51
    ds_write_b128 v5, v[44:47] offset:8192
    ds_write_b128 v5, v[48:51] offset:9216
    v_add_f32 v32, v16, v17
    v_add_f32 v40, v18, v19
    v_add_f32 v33, v24, v25
    v_add_f32 v41, v26, v27
    v_add_f32 v32, v32, v20
    v_add_f32 v40, v40, v21
    v_add_f32 v33, v33, v28
    v_add_f32 v41, v41, v29
    v_add_f32 v32, v32, v22
    v_add_f32 v40, v40, v23
    v_add_f32 v33, v33, v30
    v_add_f32 v41, v41, v31
    v_add_f32 v32, v32, v40
    v_add_f32 v33, v33, v41
    s_nop 0
    v_add_f32_dpp v32, v32, v32 quad_perm:[1,0,3,2] row_mask:0xf bank_mask:0xf
    v_add_f32_dpp v33, v33, v33 quad_perm:[1,0,3,2] row_mask:0xf bank_mask:0xf
    s_nop 0
    v_add_f32_dpp v32, v32, v32 quad_perm:[2,3,0,1] row_mask:0xf bank_mask:0xf
    v_add_f32_dpp v33, v33, v33 quad_perm:[2,3,0,1] row_mask:0xf bank_mask:0xf
    s_nop 0
    v_add_f32_dpp v32, v32, v32 row_half_mirror row_mask:0xf bank_mask:0xf
    v_add_f32_dpp v33, v33, v33 row_half_mirror row_mask:0xf bank_mask:0xf
    s_nop 0
    v_add_f32_dpp v32, v32, v32 row_mirror row_mask:0xf bank_mask:0xf
    v_add_f32_dpp v33, v33, v33 row_mirror row_mask:0xf bank_mask:0xf
    s_nop 0
    v_add_f32_dpp v32, v32, v32 row_bcast:15 row_mask:0xa bank_mask:0xf
    v_add_f32_dpp v33, v33, v33 row_bcast:15 row_mask:0xa bank_mask:0xf
    s_nop 0
    v_add_f32_dpp v32, v32, v32 row_bcast:31 row_mask:0xc bank_mask:0xf
    v_add_f32_dpp v33, v33, v33 row_bcast:31 row_mask:0xc bank_mask:0xf
    v_readlane_b32 s40, v32, 63
    v_readlane_b32 s41, v33, 63
    s_nop 0
    v_mul_f32 v34, s40, v3
    v_mul_f32 v35, s41, v3
    v_sub_f32 v40, v16, v34
    v_mul_f32 v32, v40, v40
    v_sub_f32 v42, v24, v35
    v_mul_f32 v33, v42, v42
    v_sub_f32 v41, v17, v34
    v_fmac_f32 v32, v41, v41
    v_sub_f32 v43, v25, v35
    v_fmac_f32 v33, v43, v43
    v_sub_f32 v40, v18, v34
    v_fmac_f32 v32, v40, v40
    v_sub_f32 v42, v26, v35
    v_fmac_f32 v33, v42, v42
    v_sub_f32 v41, v19, v34
    v_fmac_f32 v32, v41, v41
    v_sub_f32 v43, v27, v35
    v_fmac_f32 v33, v43, v43
    v_sub_f32 v40, v20, v34
    v_fmac_f32 v32, v40, v40
    v_sub_f32 v42, v28, v35
    v_fmac_f32 v33, v42, v42
    v_sub_f32 v41, v21, v34
    v_fmac_f32 v32, v41, v41
    v_sub_f32 v43, v29, v35
    v_fmac_f32 v33, v43, v43
    v_sub_f32 v40, v22, v34
    v_fmac_f32 v32, v40, v40
    v_sub_f32 v42, v30, v35
    v_fmac_f32 v33, v42, v42
    v_sub_f32 v41, v23, v34
    v_fmac_f32 v32, v41, v41
    v_sub_f32 v43, v31, v35
    v_fmac_f32 v33, v43, v43
    v_add_f32_dpp v32, v32, v32 quad_perm:[1,0,3,2] row_mask:0xf bank_mask:0xf
    s_nop 0
    v_add_f32_dpp v33, v33, v33 quad_perm:[1,0,3,2] row_mask:0xf bank_mask:0xf
    v_add_f32_dpp v32, v32, v32 quad_perm:[2,3,0,1] row_mask:0xf bank_mask:0xf
    s_nop 0
    v_add_f32_dpp v33, v33, v33 quad_perm:[2,3,0,1] row_mask:0xf bank_mask:0xf
    v_add_f32_dpp v32, v32, v32 row_half_mirror row_mask:0xf bank_mask:0xf
    s_nop 0
    v_add_f32_dpp v33, v33, v33 row_half_mirror row_mask:0xf bank_mask:0xf
    v_add_f32_dpp v32, v32, v32 row_mirror row_mask:0xf bank_mask:0xf
    s_nop 0
    v_add_f32_dpp v33, v33, v33 row_mirror row_mask:0xf bank_mask:0xf
    v_add_f32_dpp v32, v32, v32 row_bcast:15 row_mask:0xa bank_mask:0xf
    s_nop 0
    v_add_f32_dpp v33, v33, v33 row_bcast:15 row_mask:0xa bank_mask:0xf
    v_add_f32_dpp v32, v32, v32 row_bcast:31 row_mask:0xc bank_mask:0xf
    s_nop 0
    v_add_f32_dpp v33, v33, v33 row_bcast:31 row_mask:0xc bank_mask:0xf
    v_readlane_b32 s40, v32, 63
    v_readlane_b32 s41, v33, 63
    s_nop 0
    v_mul_f32 v36, s40, v3
    v_mul_f32 v37, s41, v3
    v_cvt_pk_bf16_f32 v38, v34, v35
    v_lshlrev_b32 v34, 16, v38
    v_and_b32 v35, 0xffff0000, v38
    v_cvt_pk_bf16_f32 v38, v36, v37
    v_lshlrev_b32 v36, 16, v38
    v_and_b32 v37, 0xffff0000, v38
    v_add_f32 v36, v36, v4
    v_add_f32 v37, v37, v4
    v_cvt_pk_bf16_f32 v38, v36, v37
    v_lshlrev_b32 v36, 16, v38
    v_and_b32 v37, 0xffff0000, v38
    v_sqrt_f32 v36, v36
    v_sqrt_f32 v37, v37
    s_nop 0
    v_cvt_pk_bf16_f32 v38, v36, v37
    v_lshlrev_b32 v36, 16, v38
    v_and_b32 v37, 0xffff0000, v38
    v_rcp_f32 v36, v36
    v_rcp_f32 v37, v37
    v_sub_f32 v40, v16, v34
    v_sub_f32 v41, v17, v34
    v_sub_f32 v42, v24, v35
    v_sub_f32 v43, v25, v35
    v_cvt_pk_bf16_f32 v38, v40, v41
    v_lshlrev_b32 v40, 16, v38
    v_and_b32 v41, 0xffff0000, v38
    v_cvt_pk_bf16_f32 v39, v42, v43
    v_lshlrev_b32 v42, 16, v39
    v_and_b32 v43, 0xffff0000, v39
    v_mul_f32 v40, v40, v36
    v_mul_f32 v41, v41, v36
    v_mul_f32 v42, v42, v37
    v_mul_f32 v43, v43, v37
    v_cvt_pk_bf16_f32 v44, v40, v41
    v_lshlrev_b32 v16, 16, v44
    v_and_b32 v17, 0xffff0000, v44
    v_cvt_pk_bf16_f32 v48, v42, v43
    v_lshlrev_b32 v24, 16, v48
    v_and_b32 v25, 0xffff0000, v48
    v_sub_f32 v40, v18, v34
    v_sub_f32 v41, v19, v34
    v_sub_f32 v42, v26, v35
    v_sub_f32 v43, v27, v35
    v_cvt_pk_bf16_f32 v38, v40, v41
    v_lshlrev_b32 v40, 16, v38
    v_and_b32 v41, 0xffff0000, v38
    v_cvt_pk_bf16_f32 v39, v42, v43
    v_lshlrev_b32 v42, 16, v39
    v_and_b32 v43, 0xffff0000, v39
    v_mul_f32 v40, v40, v36
    v_mul_f32 v41, v41, v36
    v_mul_f32 v42, v42, v37
    v_mul_f32 v43, v43, v37
    v_cvt_pk_bf16_f32 v45, v40, v41
    v_lshlrev_b32 v18, 16, v45
    v_and_b32 v19, 0xffff0000, v45
    v_cvt_pk_bf16_f32 v49, v42, v43
    v_lshlrev_b32 v26, 16, v49
    v_and_b32 v27, 0xffff0000, v49
    v_sub_f32 v40, v20, v34
    v_sub_f32 v41, v21, v34
    v_sub_f32 v42, v28, v35
    v_sub_f32 v43, v29, v35
    v_cvt_pk_bf16_f32 v38, v40, v41
    v_lshlrev_b32 v40, 16, v38
    v_and_b32 v41, 0xffff0000, v38
    v_cvt_pk_bf16_f32 v39, v42, v43
    v_lshlrev_b32 v42, 16, v39
    v_and_b32 v43, 0xffff0000, v39
    v_mul_f32 v40, v40, v36
    v_mul_f32 v41, v41, v36
    v_mul_f32 v42, v42, v37
    v_mul_f32 v43, v43, v37
    v_cvt_pk_bf16_f32 v46, v40, v41
    v_lshlrev_b32 v20, 16, v46
    v_and_b32 v21, 0xffff0000, v46
    v_cvt_pk_bf16_f32 v50, v42, v43
    v_lshlrev_b32 v28, 16, v50
    v_and_b32 v29, 0xffff0000, v50
    v_sub_f32 v40, v22, v34
    v_sub_f32 v41, v23, v34
    v_sub_f32 v42, v30, v35
    v_sub_f32 v43, v31, v35
    v_cvt_pk_bf16_f32 v38, v40, v41
    v_lshlrev_b32 v40, 16, v38
    v_and_b32 v41, 0xffff0000, v38
    v_cvt_pk_bf16_f32 v39, v42, v43
    v_lshlrev_b32 v42, 16, v39
    v_and_b32 v43, 0xffff0000, v39
    v_mul_f32 v40, v40, v36
    v_mul_f32 v41, v41, v36
    v_mul_f32 v42, v42, v37
    v_mul_f32 v43, v43, v37
    v_cvt_pk_bf16_f32 v47, v40, v41
    v_lshlrev_b32 v22, 16, v47
    v_and_b32 v23, 0xffff0000, v47
    v_cvt_pk_bf16_f32 v51, v42, v43
    v_lshlrev_b32 v30, 16, v51
    v_and_b32 v31, 0xffff0000, v51
    ds_write_b128 v5, v[44:47] offset:16384
    ds_write_b128 v5, v[48:51] offset:17408
    s_waitcnt lgkmcnt(0)
    s_barrier
    ds_read_b32 v48, v6 offset:0
    ds_read_b32 v49, v6 offset:1024
    ds_read_b32 v50, v6 offset:2048
    ds_read_b32 v51, v6 offset:3072
    ds_read_b32 v52, v6 offset:4096
    ds_read_b32 v53, v6 offset:5120
    ds_read_b32 v54, v6 offset:6144
    ds_read_b32 v55, v6 offset:7168
    ds_read_b32 v56, v6 offset:8192
    ds_read_b32 v57, v6 offset:9216
    ds_read_b32 v58, v6 offset:10240
    ds_read_b32 v59, v6 offset:11264
    ds_read_b32 v60, v6 offset:12288
    ds_read_b32 v61, v6 offset:13312
    ds_read_b32 v62, v6 offset:14336
    ds_read_b32 v63, v6 offset:15360
    ds_read_b32 v64, v6 offset:16384
    ds_read_b32 v65, v6 offset:17408
    ds_read_b32 v66, v6 offset:18432
    ds_read_b32 v67, v6 offset:19456
    ds_read_b32 v68, v6 offset:20480
    ds_read_b32 v69, v6 offset:21504
    ds_read_b32 v70, v6 offset:22528
    ds_read_b32 v71, v6 offset:23552
    s_mov_b32 s42, 0x05040100
    s_mov_b32 s43, 0x07060302
    s_waitcnt lgkmcnt(15)
    v_perm_b32 v72, v49, v48, s42
    v_perm_b32 v76, v49, v48, s43
    v_perm_b32 v73, v51, v50, s42
    v_perm_b32 v77, v51, v50, s43
    v_perm_b32 v74, v53, v52, s42
    v_perm_b32 v78, v53, v52, s43
    v_perm_b32 v75, v55, v54, s42
    v_perm_b32 v79, v55, v54, s43
    buffer_store_dwordx4 v[72:75], v7, s[24:27], s36 offen
    buffer_store_dwordx4 v[76:79], v7, s[24:27], s36 offen offset:16
    s_waitcnt lgkmcnt(8)
    v_perm_b32 v80, v57, v56, s42
    v_perm_b32 v84, v57, v56, s43
    v_perm_b32 v81, v59, v58, s42
    v_perm_b32 v85, v59, v58, s43
    v_perm_b32 v82, v61, v60, s42
    v_perm_b32 v86, v61, v60, s43
    v_perm_b32 v83, v63, v62, s42
    v_perm_b32 v87, v63, v62, s43
    buffer_store_dwordx4 v[80:83], v7, s[28:31], s36 offen
    buffer_store_dwordx4 v[84:87], v7, s[28:31], s36 offen offset:16
    s_waitcnt lgkmcnt(0)
    v_perm_b32 v88, v65, v64, s42
    v_perm_b32 v92, v65, v64, s43
    v_perm_b32 v89, v67, v66, s42
    v_perm_b32 v93, v67, v66, s43
    v_perm_b32 v90, v69, v68, s42
    v_perm_b32 v94, v69, v68, s43
    v_perm_b32 v91, v71, v70, s42
    v_perm_b32 v95, v71, v70, s43
    buffer_store_dwordx4 v[88:91], v7, s[32:35], s36 offen
    buffer_store_dwordx4 v[92:95], v7, s[32:35], s36 offen offset:16
    s_endpgm
k0_pf:
    s_load_dwordx2 s[18:19], s[0:1], 64
    s_waitcnt lgkmcnt(0)
    s_mov_b32 s20, s18
    s_and_b32 s21, s19, 0xffff
    s_mov_b32 s22, 0x700000
    s_mov_b32 s23, 0x00020000
    s_and_b32 s40, s2, 7
    s_lshr_b32 s41, s2, 3
    s_lshr_b32 s42, s41, 1
    s_lshl_b32 s43, s42, 3
    s_add_u32 s43, s43, s40
    s_cmp_lt_u32 s42, 3
    s_cbranch_scc1 pf_map_w1
    s_and_b32 s43, s40, 3
    s_add_u32 s43, s43, 24
pf_map_w1:
    s_and_b32 s41, s41, 1
    s_lshl_b32 s41, s41, 2
    s_add_u32 s41, s41, s3
    s_mul_i32 s41, s41, 917504
    s_lshl_b32 s43, s43, 7
    s_add_u32 s41, s41, s43
    v_lshrrev_b32 v2, 3, v0
    s_mov_b32 s42, 3584
    v_mul_u32_u24 v2, s42, v2
    v_and_b32 v3, 7, v0
    v_lshlrev_b32 v3, 4, v3
    v_add_u32 v2, v2, v3
    buffer_load_dwordx4 v[8:11], v2, s[20:23], s41 offen
    s_add_u32 s41, s41, 28672
    buffer_load_dwordx4 v[12:15], v2, s[20:23], s41 offen
    s_add_u32 s41, s41, 28672
    buffer_load_dwordx4 v[16:19], v2, s[20:23], s41 offen
    s_add_u32 s41, s41, 28672
    buffer_load_dwordx4 v[20:23], v2, s[20:23], s41 offen
    s_add_u32 s41, s41, 28672
    buffer_load_dwordx4 v[24:27], v2, s[20:23], s41 offen
    s_add_u32 s41, s41, 28672
    buffer_load_dwordx4 v[28:31], v2, s[20:23], s41 offen
    s_add_u32 s41, s41, 28672
    buffer_load_dwordx4 v[32:35], v2, s[20:23], s41 offen
    s_add_u32 s41, s41, 28672
    buffer_load_dwordx4 v[36:39], v2, s[20:23], s41 offen
    s_add_u32 s41, s41, 28672
    s_waitcnt vmcnt(7)
    buffer_load_dwordx4 v[40:43], v2, s[20:23], s41 offen
    s_add_u32 s41, s41, 28672
    s_waitcnt vmcnt(7)
    buffer_load_dwordx4 v[44:47], v2, s[20:23], s41 offen
    s_add_u32 s41, s41, 28672
    s_waitcnt vmcnt(7)
    buffer_load_dwordx4 v[48:51], v2, s[20:23], s41 offen
    s_add_u32 s41, s41, 28672
    s_waitcnt vmcnt(7)
    buffer_load_dwordx4 v[52:55], v2, s[20:23], s41 offen
    s_add_u32 s41, s41, 28672
    s_waitcnt vmcnt(7)
    buffer_load_dwordx4 v[56:59], v2, s[20:23], s41 offen
    s_add_u32 s41, s41, 28672
    s_waitcnt vmcnt(7)
    buffer_load_dwordx4 v[60:63], v2, s[20:23], s41 offen
    s_add_u32 s41, s41, 28672
    s_waitcnt vmcnt(7)
    buffer_load_dwordx4 v[64:67], v2, s[20:23], s41 offen
    s_add_u32 s41, s41, 28672
    s_waitcnt vmcnt(7)
    buffer_load_dwordx4 v[68:71], v2, s[20:23], s41 offen
    s_add_u32 s41, s41, 28672
    s_waitcnt vmcnt(7)
    buffer_load_dwordx4 v[8:11], v2, s[20:23], s41 offen
    s_add_u32 s41, s41, 28672
    s_waitcnt vmcnt(7)
    buffer_load_dwordx4 v[12:15], v2, s[20:23], s41 offen
    s_add_u32 s41, s41, 28672
    s_waitcnt vmcnt(7)
    buffer_load_dwordx4 v[16:19], v2, s[20:23], s41 offen
    s_add_u32 s41, s41, 28672
    s_waitcnt vmcnt(7)
    buffer_load_dwordx4 v[20:23], v2, s[20:23], s41 offen
    s_add_u32 s41, s41, 28672
    s_waitcnt vmcnt(7)
    buffer_load_dwordx4 v[24:27], v2, s[20:23], s41 offen
    s_add_u32 s41, s41, 28672
    s_waitcnt vmcnt(7)
    buffer_load_dwordx4 v[28:31], v2, s[20:23], s41 offen
    s_add_u32 s41, s41, 28672
    s_waitcnt vmcnt(7)
    buffer_load_dwordx4 v[32:35], v2, s[20:23], s41 offen
    s_add_u32 s41, s41, 28672
    s_waitcnt vmcnt(7)
    buffer_load_dwordx4 v[36:39], v2, s[20:23], s41 offen
    s_add_u32 s41, s41, 28672
    s_waitcnt vmcnt(7)
    buffer_load_dwordx4 v[40:43], v2, s[20:23], s41 offen
    s_add_u32 s41, s41, 28672
    s_waitcnt vmcnt(7)
    buffer_load_dwordx4 v[44:47], v2, s[20:23], s41 offen
    s_add_u32 s41, s41, 28672
    s_waitcnt vmcnt(7)
    buffer_load_dwordx4 v[48:51], v2, s[20:23], s41 offen
    s_add_u32 s41, s41, 28672
    s_waitcnt vmcnt(7)
    buffer_load_dwordx4 v[52:55], v2, s[20:23], s41 offen
    s_add_u32 s41, s41, 28672
    s_waitcnt vmcnt(7)
    buffer_load_dwordx4 v[56:59], v2, s[20:23], s41 offen
    s_add_u32 s41, s41, 28672
    s_waitcnt vmcnt(7)
    buffer_load_dwordx4 v[60:63], v2, s[20:23], s41 offen
    s_add_u32 s41, s41, 28672
    s_waitcnt vmcnt(7)
    buffer_load_dwordx4 v[64:67], v2, s[20:23], s41 offen
    s_add_u32 s41, s41, 28672
    s_waitcnt vmcnt(7)
    buffer_load_dwordx4 v[68:71], v2, s[20:23], s41 offen
    s_add_u32 s41, s41, 28672
    s_waitcnt vmcnt(7)
    s_waitcnt vmcnt(0)
    s_endpgm
k0_end:
    s_endpgm
.globl k1_kernel
.p2align 8
.type k1_kernel,@function
k1_kernel:
    s_load_dwordx2 s[4:5], s[0:1], 64
    s_load_dwordx2 s[6:7], s[0:1], 72
    s_load_dwordx2 s[8:9], s[0:1], 112
    s_load_dwordx2 s[10:11], s[0:1], 48
    v_lshrrev_b32 v1, 6, v0
    v_mov_b32 v127, v0
    v_and_b32 v0, 63, v0
    v_readfirstlane_b32 s3, v1
    s_cmp_ge_u32 s2, 768
    s_cbranch_scc1 k1_end
    s_cmp_ge_u32 s2, 736
    s_cbranch_scc1 k1_pf
    s_cmp_ge_u32 s2, 224
    s_cbranch_scc1 k1_conv
    s_and_b32 s12, s2, 7
    s_lshr_b32 s13, s2, 3
    s_lshr_b32 s14, s13, 3
    s_lshl_b32 s14, s14, 3
    s_add_u32 s14, s14, s12
    s_and_b32 s15, s13, 7
    s_cmp_lt_u32 s13, 24
    s_cbranch_scc1 k1_g_map
    s_and_b32 s14, s12, 3
    s_add_u32 s14, s14, 24
    s_and_b32 s15, s12, 4
    s_add_u32 s15, s15, s13
    s_sub_u32 s15, s15, 24
k1_g_map:
    s_waitcnt lgkmcnt(0)
    s_mov_b32 s20, s4
    s_and_b32 s21, s5, 0xffff
    s_mov_b32 s22, 0x700000
    s_mov_b32 s23, 0x00020000
    s_add_u32 s24, s8, 0x400000
    s_addc_u32 s25, s9, 0
    s_and_b32 s25, s25, 0xffff
    s_mov_b32 s26, 0x200000
    s_mov_b32 s27, 0x00020000
    s_mov_b32 s28, s6
    s_and_b32 s29, s7, 0xffff
    s_mov_b32 s30, 0xe00
    s_mov_b32 s31, 0x00020000
    s_add_u32 s32, s8, 0x600000
    s_addc_u32 s33, s9, 0
    s_and_b32 s33, s33, 0xffff
    s_mov_b32 s34, 0x1c0000
    s_mov_b32 s35, 0x00020000
    s_load_dwordx2 s[36:37], s[0:1], 80
    s_lshr_b32 s38, s2, 3
    s_lshl_b32 s38, s38, 2
    s_add_u32 s38, s38, s3
    s_mul_i32 s39, s38, 0x925
    s_lshr_b32 s39, s39, 16
    s_mul_i32 s16, s39, 28
    s_sub_u32 s38, s38, s16
    s_lshl_b32 s39, s39, 3
    s_and_b32 s16, s2, 7
    s_add_u32 s39, s39, s16
    s_lshl_b32 s39, s39, 7
    s_mul_i32 s38, s38, 262144
    s_add_u32 s38, s38, s39
    v_lshrrev_b32 v96, 3, v0
    v_lshlrev_b32 v96, 12, v96
    v_and_b32 v97, 7, v0
    v_lshlrev_b32 v97, 4, v97
    v_add_u32 v96, v96, v97
    s_waitcnt lgkmcnt(0)
    s_mov_b32 s80, s36
    s_and_b32 s81, s37, 0xffff
    s_mov_b32 s82, 0x700000
    s_mov_b32 s83, 0x00020000
    s_and_b32 s60, s3, 1
    s_lshr_b32 s61, s3, 1
    v_lshrrev_b32 v2, 3, v0
    s_mov_b32 s62, 3584
    v_mul_u32_u24 v2, s62, v2
    v_lshrrev_b32 v3, 4, v0
    v_and_b32 v3, 1, v3
    v_lshlrev_b32 v3, 2, v3
    v_and_b32 v4, 7, v0
    v_xor_b32 v3, v3, v4
    v_lshlrev_b32 v3, 4, v3
    v_add_u32 v2, v2, v3
    v_lshlrev_b32 v3, 4, v0
    s_mul_i32 s62, s3, 57344
    s_lshl_b32 s63, s14, 7
    s_add_u32 s62, s62, s63
    s_add_u32 s63, s62, 28672
    s_lshl_b32 s64, s3, 14
    s_lshl_b32 s65, s15, 10
    s_add_u32 s64, s64, s65
    s_add_u32 s65, s64, 8192
    s_lshl_b32 s66, s3, 11
    v_and_b32 v4, 15, v0
    v_lshrrev_b32 v5, 2, v4
    v_and_b32 v6, 3, v0
    v_lshrrev_b32 v7, 5, v0
    v_lshrrev_b32 v8, 4, v0
    v_and_b32 v8, 1, v8
    v_lshlrev_b32 v9, 3, v7
    v_add_u32 v9, v9, v5
    v_lshlrev_b32 v9, 3, v9
    v_lshlrev_b32 v10, 1, v8
    v_lshrrev_b32 v11, 1, v6
    v_add_u32 v10, v10, v11
    s_lshl_b32 s67, s60, 2
    v_add_u32 v10, s67, v10
    v_lshrrev_b32 v11, 1, v5
    v_and_b32 v11, 1, v11
    v_lshlrev_b32 v11, 2, v11
    v_xor_b32 v10, v10, v11
    v_add_u32 v9, v9, v10
    v_lshlrev_b32 v9, 4, v9
    v_and_b32 v10, 1, v6
    v_lshlrev_b32 v10, 3, v10
    v_add_u32 v4, v9, v10
    v_lshlrev_b32 v5, 6, v7
    v_and_b32 v6, 31, v0
    v_add_u32 v5, v5, v6
    s_lshl_b32 s67, s61, 5
    v_add_u32 v5, s67, v5
    v_lshlrev_b32 v5, 4, v5
    v_add_u32 v5, 0x2000, v5
    v_lshrrev_b32 v6, 5, v0
    v_lshlrev_b32 v6, 3, v6
    s_lshl_b32 s67, s60, 6
    v_add_u32 v6, s67, v6
    s_lshl_b32 s67, s14, 7
    buffer_load_dwordx2 v[64:65], v6, s[28:31], s67 offen offset:0
    buffer_load_dwordx2 v[66:67], v6, s[28:31], s67 offen offset:16
    buffer_load_dwordx2 v[68:69], v6, s[28:31], s67 offen offset:32
    buffer_load_dwordx2 v[70:71], v6, s[28:31], s67 offen offset:48
    v_mov_b32 v16, 0
    v_mov_b32 v17, 0
    v_mov_b32 v18, 0
    v_mov_b32 v19, 0
    v_mov_b32 v20, 0
    v_mov_b32 v21, 0
    v_mov_b32 v22, 0
    v_mov_b32 v23, 0
    v_mov_b32 v24, 0
    v_mov_b32 v25, 0
    v_mov_b32 v26, 0
    v_mov_b32 v27, 0
    v_mov_b32 v28, 0
    v_mov_b32 v29, 0
    v_mov_b32 v30, 0
    v_mov_b32 v31, 0
    s_add_u32 m0, s66, 0
    s_nop 0
    buffer_load_dwordx4 v2, s[20:23], s62 offen lds
    s_add_u32 m0, s66, 1024
    s_nop 0
    buffer_load_dwordx4 v2, s[20:23], s63 offen lds
    s_add_u32 m0, s66, 8192
    s_nop 0
    buffer_load_dwordx4 v3, s[24:27], s64 offen lds
    s_add_u32 m0, s66, 9216
    s_nop 0
    buffer_load_dwordx4 v3, s[24:27], s65 offen lds
    s_add_u32 s62, s62, 229376
    s_add_u32 s63, s63, 229376
    s_add_u32 s64, s64, 0x10000
    s_add_u32 s65, s65, 0x10000
    s_add_u32 m0, s66, 16384
    s_nop 0
    buffer_load_dwordx4 v2, s[20:23], s62 offen lds
    s_add_u32 m0, s66, 17408
    s_nop 0
    buffer_load_dwordx4 v2, s[20:23], s63 offen lds
    s_add_u32 m0, s66, 24576
    s_nop 0
    buffer_load_dwordx4 v3, s[24:27], s64 offen lds
    s_add_u32 m0, s66, 25600
    s_nop 0
    buffer_load_dwordx4 v3, s[24:27], s65 offen lds
    s_add_u32 s62, s62, 229376
    s_add_u32 s63, s63, 229376
    s_add_u32 s64, s64, 0x10000
    s_add_u32 s65, s65, 0x10000
    s_waitcnt vmcnt(4)
    s_barrier
    s_add_u32 m0, s66, 32768
    s_nop 0
    buffer_load_dwordx4 v2, s[20:23], s62 offen lds
    s_add_u32 m0, s66, 33792
    s_nop 0
    buffer_load_dwordx4 v2, s[20:23], s63 offen lds
    s_add_u32 m0, s66, 40960
    s_nop 0
    buffer_load_dwordx4 v3, s[24:27], s64 offen lds
    s_add_u32 m0, s66, 41984
    s_nop 0
    buffer_load_dwordx4 v3, s[24:27], s65 offen lds
    s_add_u32 s62, s62, 229376
    s_add_u32 s63, s63, 229376
    s_add_u32 s64, s64, 0x10000
    s_add_u32 s65, s65, 0x10000
    ds_read_b64_tr_b16 v[32:33], v4 offset:0
    ds_read_b64_tr_b16 v[34:35], v4 offset:512
    ds_read_b128 v[48:51], v5 offset:0
    ds_read_b64_tr_b16 v[36:37], v4 offset:2048
    ds_read_b64_tr_b16 v[38:39], v4 offset:2560
    ds_read_b128 v[52:55], v5 offset:2048
    ds_read_b64_tr_b16 v[40:41], v4 offset:4096
    ds_read_b64_tr_b16 v[42:43], v4 offset:4608
    ds_read_b128 v[56:59], v5 offset:4096
    ds_read_b64_tr_b16 v[44:45], v4 offset:6144
    ds_read_b64_tr_b16 v[46:47], v4 offset:6656
    ds_read_b128 v[60:63], v5 offset:6144
    s_waitcnt lgkmcnt(9)
    v_mfma_f32_32x32x16_bf16 v[16:31], v[32:35], v[48:51], v[16:31]
    s_waitcnt lgkmcnt(6)
    v_mfma_f32_32x32x16_bf16 v[16:31], v[36:39], v[52:55], v[16:31]
    s_waitcnt lgkmcnt(3)
    v_mfma_f32_32x32x16_bf16 v[16:31], v[40:43], v[56:59], v[16:31]
    s_waitcnt lgkmcnt(0)
    v_mfma_f32_32x32x16_bf16 v[16:31], v[44:47], v[60:63], v[16:31]
    s_waitcnt vmcnt(4)
    s_barrier
    s_add_u32 m0, s66, 0
    s_nop 0
    buffer_load_dwordx4 v2, s[20:23], s62 offen lds
    s_add_u32 m0, s66, 1024
    s_nop 0
    buffer_load_dwordx4 v2, s[20:23], s63 offen lds
    s_add_u32 m0, s66, 8192
    s_nop 0
    buffer_load_dwordx4 v3, s[24:27], s64 offen lds
    s_add_u32 m0, s66, 9216
    s_nop 0
    buffer_load_dwordx4 v3, s[24:27], s65 offen lds
    s_add_u32 s62, s62, 229376
    s_add_u32 s63, s63, 229376
    s_add_u32 s64, s64, 0x10000
    s_add_u32 s65, s65, 0x10000
    ds_read_b64_tr_b16 v[32:33], v4 offset:16384
    ds_read_b64_tr_b16 v[34:35], v4 offset:16896
    ds_read_b128 v[48:51], v5 offset:16384
    ds_read_b64_tr_b16 v[36:37], v4 offset:18432
    ds_read_b64_tr_b16 v[38:39], v4 offset:18944
    ds_read_b128 v[52:55], v5 offset:18432
    ds_read_b64_tr_b16 v[40:41], v4 offset:20480
    ds_read_b64_tr_b16 v[42:43], v4 offset:20992
    ds_read_b128 v[56:59], v5 offset:20480
    ds_read_b64_tr_b16 v[44:45], v4 offset:22528
    ds_read_b64_tr_b16 v[46:47], v4 offset:23040
    ds_read_b128 v[60:63], v5 offset:22528
    s_waitcnt lgkmcnt(9)
    v_mfma_f32_32x32x16_bf16 v[16:31], v[32:35], v[48:51], v[16:31]
    s_waitcnt lgkmcnt(6)
    v_mfma_f32_32x32x16_bf16 v[16:31], v[36:39], v[52:55], v[16:31]
    s_waitcnt lgkmcnt(3)
    v_mfma_f32_32x32x16_bf16 v[16:31], v[40:43], v[56:59], v[16:31]
    s_waitcnt lgkmcnt(0)
    v_mfma_f32_32x32x16_bf16 v[16:31], v[44:47], v[60:63], v[16:31]
    s_waitcnt vmcnt(4)
    s_barrier
    s_add_u32 m0, s66, 16384
    s_nop 0
    buffer_load_dwordx4 v2, s[20:23], s62 offen lds
    s_add_u32 m0, s66, 17408
    s_nop 0
    buffer_load_dwordx4 v2, s[20:23], s63 offen lds
    s_add_u32 m0, s66, 24576
    s_nop 0
    buffer_load_dwordx4 v3, s[24:27], s64 offen lds
    s_add_u32 m0, s66, 25600
    s_nop 0
    buffer_load_dwordx4 v3, s[24:27], s65 offen lds
    s_add_u32 s62, s62, 229376
    s_add_u32 s63, s63, 229376
    s_add_u32 s64, s64, 0x10000
    s_add_u32 s65, s65, 0x10000
    ds_read_b64_tr_b16 v[32:33], v4 offset:32768
    ds_read_b64_tr_b16 v[34:35], v4 offset:33280
    ds_read_b128 v[48:51], v5 offset:32768
    ds_read_b64_tr_b16 v[36:37], v4 offset:34816
    ds_read_b64_tr_b16 v[38:39], v4 offset:35328
    ds_read_b128 v[52:55], v5 offset:34816
    ds_read_b64_tr_b16 v[40:41], v4 offset:36864
    ds_read_b64_tr_b16 v[42:43], v4 offset:37376
    ds_read_b128 v[56:59], v5 offset:36864
    ds_read_b64_tr_b16 v[44:45], v4 offset:38912
    ds_read_b64_tr_b16 v[46:47], v4 offset:39424
    ds_read_b128 v[60:63], v5 offset:38912
    s_waitcnt lgkmcnt(9)
    v_mfma_f32_32x32x16_bf16 v[16:31], v[32:35], v[48:51], v[16:31]
    s_waitcnt lgkmcnt(6)
    v_mfma_f32_32x32x16_bf16 v[16:31], v[36:39], v[52:55], v[16:31]
    s_waitcnt lgkmcnt(3)
    v_mfma_f32_32x32x16_bf16 v[16:31], v[40:43], v[56:59], v[16:31]
    s_waitcnt lgkmcnt(0)
    v_mfma_f32_32x32x16_bf16 v[16:31], v[44:47], v[60:63], v[16:31]
    s_waitcnt vmcnt(4)
    s_barrier
    s_add_u32 m0, s66, 32768
    s_nop 0
    buffer_load_dwordx4 v2, s[20:23], s62 offen lds
    s_add_u32 m0, s66, 33792
    s_nop 0
    buffer_load_dwordx4 v2, s[20:23], s63 offen lds
    s_add_u32 m0, s66, 40960
    s_nop 0
    buffer_load_dwordx4 v3, s[24:27], s64 offen lds
    s_add_u32 m0, s66, 41984
    s_nop 0
    buffer_load_dwordx4 v3, s[24:27], s65 offen lds
    s_add_u32 s62, s62, 229376
    s_add_u32 s63, s63, 229376
    s_add_u32 s64, s64, 0x10000
    s_add_u32 s65, s65, 0x10000
    ds_read_b64_tr_b16 v[32:33], v4 offset:0
    ds_read_b64_tr_b16 v[34:35], v4 offset:512
    ds_read_b128 v[48:51], v5 offset:0
    ds_read_b64_tr_b16 v[36:37], v4 offset:2048
    ds_read_b64_tr_b16 v[38:39], v4 offset:2560
    ds_read_b128 v[52:55], v5 offset:2048
    ds_read_b64_tr_b16 v[40:41], v4 offset:4096
    ds_read_b64_tr_b16 v[42:43], v4 offset:4608
    ds_read_b128 v[56:59], v5 offset:4096
    ds_read_b64_tr_b16 v[44:45], v4 offset:6144
    ds_read_b64_tr_b16 v[46:47], v4 offset:6656
    ds_read_b128 v[60:63], v5 offset:6144
    s_waitcnt lgkmcnt(9)
    v_mfma_f32_32x32x16_bf16 v[16:31], v[32:35], v[48:51], v[16:31]
    s_waitcnt lgkmcnt(6)
    v_mfma_f32_32x32x16_bf16 v[16:31], v[36:39], v[52:55], v[16:31]
    s_waitcnt lgkmcnt(3)
    v_mfma_f32_32x32x16_bf16 v[16:31], v[40:43], v[56:59], v[16:31]
    s_waitcnt lgkmcnt(0)
    v_mfma_f32_32x32x16_bf16 v[16:31], v[44:47], v[60:63], v[16:31]
    s_waitcnt vmcnt(4)
    s_barrier
    s_add_u32 m0, s66, 0
    s_nop 0
    buffer_load_dwordx4 v2, s[20:23], s62 offen lds
    s_add_u32 m0, s66, 1024
    s_nop 0
    buffer_load_dwordx4 v2, s[20:23], s63 offen lds
    s_add_u32 m0, s66, 8192
    s_nop 0
    buffer_load_dwordx4 v3, s[24:27], s64 offen lds
    s_add_u32 m0, s66, 9216
    s_nop 0
    buffer_load_dwordx4 v3, s[24:27], s65 offen lds
    s_add_u32 s62, s62, 229376
    s_add_u32 s63, s63, 229376
    s_add_u32 s64, s64, 0x10000
    s_add_u32 s65, s65, 0x10000
    ds_read_b64_tr_b16 v[32:33], v4 offset:16384
    ds_read_b64_tr_b16 v[34:35], v4 offset:16896
    ds_read_b128 v[48:51], v5 offset:16384
    ds_read_b64_tr_b16 v[36:37], v4 offset:18432
    ds_read_b64_tr_b16 v[38:39], v4 offset:18944
    ds_read_b128 v[52:55], v5 offset:18432
    ds_read_b64_tr_b16 v[40:41], v4 offset:20480
    ds_read_b64_tr_b16 v[42:43], v4 offset:20992
    ds_read_b128 v[56:59], v5 offset:20480
    ds_read_b64_tr_b16 v[44:45], v4 offset:22528
    ds_read_b64_tr_b16 v[46:47], v4 offset:23040
    ds_read_b128 v[60:63], v5 offset:22528
    s_waitcnt lgkmcnt(9)
    v_mfma_f32_32x32x16_bf16 v[16:31], v[32:35], v[48:51], v[16:31]
    s_waitcnt lgkmcnt(6)
    v_mfma_f32_32x32x16_bf16 v[16:31], v[36:39], v[52:55], v[16:31]
    s_waitcnt lgkmcnt(3)
    v_mfma_f32_32x32x16_bf16 v[16:31], v[40:43], v[56:59], v[16:31]
    s_waitcnt lgkmcnt(0)
    v_mfma_f32_32x32x16_bf16 v[16:31], v[44:47], v[60:63], v[16:31]
    s_waitcnt vmcnt(4)
    s_barrier
    s_add_u32 m0, s66, 16384
    s_nop 0
    buffer_load_dwordx4 v2, s[20:23], s62 offen lds
    s_add_u32 m0, s66, 17408
    s_nop 0
    buffer_load_dwordx4 v2, s[20:23], s63 offen lds
    s_add_u32 m0, s66, 24576
    s_nop 0
    buffer_load_dwordx4 v3, s[24:27], s64 offen lds
    s_add_u32 m0, s66, 25600
    s_nop 0
    buffer_load_dwordx4 v3, s[24:27], s65 offen lds
    s_add_u32 s62, s62, 229376
    s_add_u32 s63, s63, 229376
    s_add_u32 s64, s64, 0x10000
    s_add_u32 s65, s65, 0x10000
    ds_read_b64_tr_b16 v[32:33], v4 offset:32768
    ds_read_b64_tr_b16 v[34:35], v4 offset:33280
    ds_read_b128 v[48:51], v5 offset:32768
    ds_read_b64_tr_b16 v[36:37], v4 offset:34816
    ds_read_b64_tr_b16 v[38:39], v4 offset:35328
    ds_read_b128 v[52:55], v5 offset:34816
    ds_read_b64_tr_b16 v[40:41], v4 offset:36864
    ds_read_b64_tr_b16 v[42:43], v4 offset:37376
    ds_read_b128 v[56:59], v5 offset:36864
    ds_read_b64_tr_b16 v[44:45], v4 offset:38912
    ds_read_b64_tr_b16 v[46:47], v4 offset:39424
    ds_read_b128 v[60:63], v5 offset:38912
    s_waitcnt lgkmcnt(9)
    v_mfma_f32_32x32x16_bf16 v[16:31], v[32:35], v[48:51], v[16:31]
    s_waitcnt lgkmcnt(6)
    v_mfma_f32_32x32x16_bf16 v[16:31], v[36:39], v[52:55], v[16:31]
    s_waitcnt lgkmcnt(3)
    v_mfma_f32_32x32x16_bf16 v[16:31], v[40:43], v[56:59], v[16:31]
    s_waitcnt lgkmcnt(0)
    v_mfma_f32_32x32x16_bf16 v[16:31], v[44:47], v[60:63], v[16:31]
    s_waitcnt vmcnt(4)
    s_barrier
    s_add_u32 m0, s66, 32768
    s_nop 0
    buffer_load_dwordx4 v2, s[20:23], s62 offen lds
    s_add_u32 m0, s66, 33792
    s_nop 0
    buffer_load_dwordx4 v2, s[20:23], s63 offen lds
    s_add_u32 m0, s66, 40960
    s_nop 0
    buffer_load_dwordx4 v3, s[24:27], s64 offen lds
    s_add_u32 m0, s66, 41984
    s_nop 0
    buffer_load_dwordx4 v3, s[24:27], s65 offen lds
    s_add_u32 s62, s62, 229376
    s_add_u32 s63, s63, 229376
    s_add_u32 s64, s64, 0x10000
    s_add_u32 s65, s65, 0x10000
    ds_read_b64_tr_b16 v[32:33], v4 offset:0
    ds_read_b64_tr_b16 v[34:35], v4 offset:512
    ds_read_b128 v[48:51], v5 offset:0
    ds_read_b64_tr_b16 v[36:37], v4 offset:2048
    ds_read_b64_tr_b16 v[38:39], v4 offset:2560
    ds_read_b128 v[52:55], v5 offset:2048
    ds_read_b64_tr_b16 v[40:41], v4 offset:4096
    ds_read_b64_tr_b16 v[42:43], v4 offset:4608
    ds_read_b128 v[56:59], v5 offset:4096
    ds_read_b64_tr_b16 v[44:45], v4 offset:6144
    ds_read_b64_tr_b16 v[46:47], v4 offset:6656
    ds_read_b128 v[60:63], v5 offset:6144
    s_waitcnt lgkmcnt(9)
    v_mfma_f32_32x32x16_bf16 v[16:31], v[32:35], v[48:51], v[16:31]
    s_waitcnt lgkmcnt(6)
    v_mfma_f32_32x32x16_bf16 v[16:31], v[36:39], v[52:55], v[16:31]
    s_waitcnt lgkmcnt(3)
    v_mfma_f32_32x32x16_bf16 v[16:31], v[40:43], v[56:59], v[16:31]
    s_waitcnt lgkmcnt(0)
    v_mfma_f32_32x32x16_bf16 v[16:31], v[44:47], v[60:63], v[16:31]
    s_waitcnt vmcnt(4)
    s_barrier
    s_add_u32 m0, s66, 0
    s_nop 0
    buffer_load_dwordx4 v2, s[20:23], s62 offen lds
    s_add_u32 m0, s66, 1024
    s_nop 0
    buffer_load_dwordx4 v2, s[20:23], s63 offen lds
    s_add_u32 m0, s66, 8192
    s_nop 0
    buffer_load_dwordx4 v3, s[24:27], s64 offen lds
    s_add_u32 m0, s66, 9216
    s_nop 0
    buffer_load_dwordx4 v3, s[24:27], s65 offen lds
    s_add_u32 s62, s62, 229376
    s_add_u32 s63, s63, 229376
    s_add_u32 s64, s64, 0x10000
    s_add_u32 s65, s65, 0x10000
    ds_read_b64_tr_b16 v[32:33], v4 offset:16384
    ds_read_b64_tr_b16 v[34:35], v4 offset:16896
    ds_read_b128 v[48:51], v5 offset:16384
    ds_read_b64_tr_b16 v[36:37], v4 offset:18432
    ds_read_b64_tr_b16 v[38:39], v4 offset:18944
    ds_read_b128 v[52:55], v5 offset:18432
    ds_read_b64_tr_b16 v[40:41], v4 offset:20480
    ds_read_b64_tr_b16 v[42:43], v4 offset:20992
    ds_read_b128 v[56:59], v5 offset:20480
    ds_read_b64_tr_b16 v[44:45], v4 offset:22528
    ds_read_b64_tr_b16 v[46:47], v4 offset:23040
    ds_read_b128 v[60:63], v5 offset:22528
    s_waitcnt lgkmcnt(9)
    v_mfma_f32_32x32x16_bf16 v[16:31], v[32:35], v[48:51], v[16:31]
    s_waitcnt lgkmcnt(6)
    v_mfma_f32_32x32x16_bf16 v[16:31], v[36:39], v[52:55], v[16:31]
    s_waitcnt lgkmcnt(3)
    v_mfma_f32_32x32x16_bf16 v[16:31], v[40:43], v[56:59], v[16:31]
    s_waitcnt lgkmcnt(0)
    v_mfma_f32_32x32x16_bf16 v[16:31], v[44:47], v[60:63], v[16:31]
    s_waitcnt vmcnt(4)
    s_barrier
    s_add_u32 m0, s66, 16384
    s_nop 0
    buffer_load_dwordx4 v2, s[20:23], s62 offen lds
    s_add_u32 m0, s66, 17408
    s_nop 0
    buffer_load_dwordx4 v2, s[20:23], s63 offen lds
    s_add_u32 m0, s66, 24576
    s_nop 0
    buffer_load_dwordx4 v3, s[24:27], s64 offen lds
    s_add_u32 m0, s66, 25600
    s_nop 0
    buffer_load_dwordx4 v3, s[24:27], s65 offen lds
    s_add_u32 s62, s62, 229376
    s_add_u32 s63, s63, 229376
    s_add_u32 s64, s64, 0x10000
    s_add_u32 s65, s65, 0x10000
    ds_read_b64_tr_b16 v[32:33], v4 offset:32768
    ds_read_b64_tr_b16 v[34:35], v4 offset:33280
    ds_read_b128 v[48:51], v5 offset:32768
    ds_read_b64_tr_b16 v[36:37], v4 offset:34816
    ds_read_b64_tr_b16 v[38:39], v4 offset:35328
    ds_read_b128 v[52:55], v5 offset:34816
    ds_read_b64_tr_b16 v[40:41], v4 offset:36864
    ds_read_b64_tr_b16 v[42:43], v4 offset:37376
    ds_read_b128 v[56:59], v5 offset:36864
    ds_read_b64_tr_b16 v[44:45], v4 offset:38912
    ds_read_b64_tr_b16 v[46:47], v4 offset:39424
    ds_read_b128 v[60:63], v5 offset:38912
    s_waitcnt lgkmcnt(9)
    v_mfma_f32_32x32x16_bf16 v[16:31], v[32:35], v[48:51], v[16:31]
    s_waitcnt lgkmcnt(6)
    v_mfma_f32_32x32x16_bf16 v[16:31], v[36:39], v[52:55], v[16:31]
    s_waitcnt lgkmcnt(3)
    v_mfma_f32_32x32x16_bf16 v[16:31], v[40:43], v[56:59], v[16:31]
    s_waitcnt lgkmcnt(0)
    v_mfma_f32_32x32x16_bf16 v[16:31], v[44:47], v[60:63], v[16:31]
    s_waitcnt vmcnt(4)
    s_barrier
    s_add_u32 m0, s66, 32768
    s_nop 0
    buffer_load_dwordx4 v2, s[20:23], s62 offen lds
    s_add_u32 m0, s66, 33792
    s_nop 0
    buffer_load_dwordx4 v2, s[20:23], s63 offen lds
    s_add_u32 m0, s66, 40960
    s_nop 0
    buffer_load_dwordx4 v3, s[24:27], s64 offen lds
    s_add_u32 m0, s66, 41984
    s_nop 0
    buffer_load_dwordx4 v3, s[24:27], s65 offen lds
    s_add_u32 s62, s62, 229376
    s_add_u32 s63, s63, 229376
    s_add_u32 s64, s64, 0x10000
    s_add_u32 s65, s65, 0x10000
    ds_read_b64_tr_b16 v[32:33], v4 offset:0
    ds_read_b64_tr_b16 v[34:35], v4 offset:512
    ds_read_b128 v[48:51], v5 offset:0
    ds_read_b64_tr_b16 v[36:37], v4 offset:2048
    ds_read_b64_tr_b16 v[38:39], v4 offset:2560
    ds_read_b128 v[52:55], v5 offset:2048
    ds_read_b64_tr_b16 v[40:41], v4 offset:4096
    ds_read_b64_tr_b16 v[42:43], v4 offset:4608
    ds_read_b128 v[56:59], v5 offset:4096
    ds_read_b64_tr_b16 v[44:45], v4 offset:6144
    ds_read_b64_tr_b16 v[46:47], v4 offset:6656
    ds_read_b128 v[60:63], v5 offset:6144
    s_waitcnt lgkmcnt(9)
    v_mfma_f32_32x32x16_bf16 v[16:31], v[32:35], v[48:51], v[16:31]
    s_waitcnt lgkmcnt(6)
    v_mfma_f32_32x32x16_bf16 v[16:31], v[36:39], v[52:55], v[16:31]
    s_waitcnt lgkmcnt(3)
    v_mfma_f32_32x32x16_bf16 v[16:31], v[40:43], v[56:59], v[16:31]
    s_waitcnt lgkmcnt(0)
    v_mfma_f32_32x32x16_bf16 v[16:31], v[44:47], v[60:63], v[16:31]
    s_waitcnt vmcnt(4)
    s_barrier
    s_add_u32 m0, s66, 0
    s_nop 0
    buffer_load_dwordx4 v2, s[20:23], s62 offen lds
    s_add_u32 m0, s66, 1024
    s_nop 0
    buffer_load_dwordx4 v2, s[20:23], s63 offen lds
    s_add_u32 m0, s66, 8192
    s_nop 0
    buffer_load_dwordx4 v3, s[24:27], s64 offen lds
    s_add_u32 m0, s66, 9216
    s_nop 0
    buffer_load_dwordx4 v3, s[24:27], s65 offen lds
    s_add_u32 s62, s62, 229376
    s_add_u32 s63, s63, 229376
    s_add_u32 s64, s64, 0x10000
    s_add_u32 s65, s65, 0x10000
    ds_read_b64_tr_b16 v[32:33], v4 offset:16384
    ds_read_b64_tr_b16 v[34:35], v4 offset:16896
    ds_read_b128 v[48:51], v5 offset:16384
    ds_read_b64_tr_b16 v[36:37], v4 offset:18432
    ds_read_b64_tr_b16 v[38:39], v4 offset:18944
    ds_read_b128 v[52:55], v5 offset:18432
    ds_read_b64_tr_b16 v[40:41], v4 offset:20480
    ds_read_b64_tr_b16 v[42:43], v4 offset:20992
    ds_read_b128 v[56:59], v5 offset:20480
    ds_read_b64_tr_b16 v[44:45], v4 offset:22528
    ds_read_b64_tr_b16 v[46:47], v4 offset:23040
    ds_read_b128 v[60:63], v5 offset:22528
    s_waitcnt lgkmcnt(9)
    v_mfma_f32_32x32x16_bf16 v[16:31], v[32:35], v[48:51], v[16:31]
    s_waitcnt lgkmcnt(6)
    v_mfma_f32_32x32x16_bf16 v[16:31], v[36:39], v[52:55], v[16:31]
    s_waitcnt lgkmcnt(3)
    v_mfma_f32_32x32x16_bf16 v[16:31], v[40:43], v[56:59], v[16:31]
    s_waitcnt lgkmcnt(0)
    v_mfma_f32_32x32x16_bf16 v[16:31], v[44:47], v[60:63], v[16:31]
    s_waitcnt vmcnt(4)
    s_barrier
    s_add_u32 m0, s66, 16384
    s_nop 0
    buffer_load_dwordx4 v2, s[20:23], s62 offen lds
    s_add_u32 m0, s66, 17408
    s_nop 0
    buffer_load_dwordx4 v2, s[20:23], s63 offen lds
    s_add_u32 m0, s66, 24576
    s_nop 0
    buffer_load_dwordx4 v3, s[24:27], s64 offen lds
    s_add_u32 m0, s66, 25600
    s_nop 0
    buffer_load_dwordx4 v3, s[24:27], s65 offen lds
    s_add_u32 s62, s62, 229376
    s_add_u32 s63, s63, 229376
    s_add_u32 s64, s64, 0x10000
    s_add_u32 s65, s65, 0x10000
    ds_read_b64_tr_b16 v[32:33], v4 offset:32768
    ds_read_b64_tr_b16 v[34:35], v4 offset:33280
    ds_read_b128 v[48:51], v5 offset:32768
    ds_read_b64_tr_b16 v[36:37], v4 offset:34816
    ds_read_b64_tr_b16 v[38:39], v4 offset:35328
    ds_read_b128 v[52:55], v5 offset:34816
    ds_read_b64_tr_b16 v[40:41], v4 offset:36864
    ds_read_b64_tr_b16 v[42:43], v4 offset:37376
    ds_read_b128 v[56:59], v5 offset:36864
    ds_read_b64_tr_b16 v[44:45], v4 offset:38912
    ds_read_b64_tr_b16 v[46:47], v4 offset:39424
    ds_read_b128 v[60:63], v5 offset:38912
    s_waitcnt lgkmcnt(9)
    v_mfma_f32_32x32x16_bf16 v[16:31], v[32:35], v[48:51], v[16:31]
    s_waitcnt lgkmcnt(6)
    v_mfma_f32_32x32x16_bf16 v[16:31], v[36:39], v[52:55], v[16:31]
    s_waitcnt lgkmcnt(3)
    v_mfma_f32_32x32x16_bf16 v[16:31], v[40:43], v[56:59], v[16:31]
    s_waitcnt lgkmcnt(0)
    v_mfma_f32_32x32x16_bf16 v[16:31], v[44:47], v[60:63], v[16:31]
    s_waitcnt vmcnt(4)
    s_barrier
    s_add_u32 m0, s66, 32768
    s_nop 0
    buffer_load_dwordx4 v2, s[20:23], s62 offen lds
    s_add_u32 m0, s66, 33792
    s_nop 0
    buffer_load_dwordx4 v2, s[20:23], s63 offen lds
    s_add_u32 m0, s66, 40960
    s_nop 0
    buffer_load_dwordx4 v3, s[24:27], s64 offen lds
    s_add_u32 m0, s66, 41984
    s_nop 0
    buffer_load_dwordx4 v3, s[24:27], s65 offen lds
    s_add_u32 s62, s62, 229376
    s_add_u32 s63, s63, 229376
    s_add_u32 s64, s64, 0x10000
    s_add_u32 s65, s65, 0x10000
    ds_read_b64_tr_b16 v[32:33], v4 offset:0
    ds_read_b64_tr_b16 v[34:35], v4 offset:512
    ds_read_b128 v[48:51], v5 offset:0
    ds_read_b64_tr_b16 v[36:37], v4 offset:2048
    ds_read_b64_tr_b16 v[38:39], v4 offset:2560
    ds_read_b128 v[52:55], v5 offset:2048
    ds_read_b64_tr_b16 v[40:41], v4 offset:4096
    ds_read_b64_tr_b16 v[42:43], v4 offset:4608
    ds_read_b128 v[56:59], v5 offset:4096
    ds_read_b64_tr_b16 v[44:45], v4 offset:6144
    ds_read_b64_tr_b16 v[46:47], v4 offset:6656
    ds_read_b128 v[60:63], v5 offset:6144
    s_waitcnt lgkmcnt(9)
    v_mfma_f32_32x32x16_bf16 v[16:31], v[32:35], v[48:51], v[16:31]
    s_waitcnt lgkmcnt(6)
    v_mfma_f32_32x32x16_bf16 v[16:31], v[36:39], v[52:55], v[16:31]
    s_waitcnt lgkmcnt(3)
    v_mfma_f32_32x32x16_bf16 v[16:31], v[40:43], v[56:59], v[16:31]
    s_waitcnt lgkmcnt(0)
    v_mfma_f32_32x32x16_bf16 v[16:31], v[44:47], v[60:63], v[16:31]
    s_waitcnt vmcnt(4)
    s_barrier
    s_add_u32 m0, s66, 0
    s_nop 0
    buffer_load_dwordx4 v2, s[20:23], s62 offen lds
    s_add_u32 m0, s66, 1024
    s_nop 0
    buffer_load_dwordx4 v2, s[20:23], s63 offen lds
    s_add_u32 m0, s66, 8192
    s_nop 0
    buffer_load_dwordx4 v3, s[24:27], s64 offen lds
    s_add_u32 m0, s66, 9216
    s_nop 0
    buffer_load_dwordx4 v3, s[24:27], s65 offen lds
    s_add_u32 s62, s62, 229376
    s_add_u32 s63, s63, 229376
    s_add_u32 s64, s64, 0x10000
    s_add_u32 s65, s65, 0x10000
    ds_read_b64_tr_b16 v[32:33], v4 offset:16384
    ds_read_b64_tr_b16 v[34:35], v4 offset:16896
    ds_read_b128 v[48:51], v5 offset:16384
    ds_read_b64_tr_b16 v[36:37], v4 offset:18432
    ds_read_b64_tr_b16 v[38:39], v4 offset:18944
    ds_read_b128 v[52:55], v5 offset:18432
    ds_read_b64_tr_b16 v[40:41], v4 offset:20480
    ds_read_b64_tr_b16 v[42:43], v4 offset:20992
    ds_read_b128 v[56:59], v5 offset:20480
    ds_read_b64_tr_b16 v[44:45], v4 offset:22528
    ds_read_b64_tr_b16 v[46:47], v4 offset:23040
    ds_read_b128 v[60:63], v5 offset:22528
    s_waitcnt lgkmcnt(9)
    v_mfma_f32_32x32x16_bf16 v[16:31], v[32:35], v[48:51], v[16:31]
    s_waitcnt lgkmcnt(6)
    v_mfma_f32_32x32x16_bf16 v[16:31], v[36:39], v[52:55], v[16:31]
    s_waitcnt lgkmcnt(3)
    v_mfma_f32_32x32x16_bf16 v[16:31], v[40:43], v[56:59], v[16:31]
    s_waitcnt lgkmcnt(0)
    v_mfma_f32_32x32x16_bf16 v[16:31], v[44:47], v[60:63], v[16:31]
    s_waitcnt vmcnt(4)
    s_barrier
    s_add_u32 m0, s66, 16384
    s_nop 0
    buffer_load_dwordx4 v2, s[20:23], s62 offen lds
    s_add_u32 m0, s66, 17408
    s_nop 0
    buffer_load_dwordx4 v2, s[20:23], s63 offen lds
    s_add_u32 m0, s66, 24576
    s_nop 0
    buffer_load_dwordx4 v3, s[24:27], s64 offen lds
    s_add_u32 m0, s66, 25600
    s_nop 0
    buffer_load_dwordx4 v3, s[24:27], s65 offen lds
    s_add_u32 s62, s62, 229376
    s_add_u32 s63, s63, 229376
    s_add_u32 s64, s64, 0x10000
    s_add_u32 s65, s65, 0x10000
    ds_read_b64_tr_b16 v[32:33], v4 offset:32768
    ds_read_b64_tr_b16 v[34:35], v4 offset:33280
    ds_read_b128 v[48:51], v5 offset:32768
    ds_read_b64_tr_b16 v[36:37], v4 offset:34816
    ds_read_b64_tr_b16 v[38:39], v4 offset:35328
    ds_read_b128 v[52:55], v5 offset:34816
    ds_read_b64_tr_b16 v[40:41], v4 offset:36864
    ds_read_b64_tr_b16 v[42:43], v4 offset:37376
    ds_read_b128 v[56:59], v5 offset:36864
    ds_read_b64_tr_b16 v[44:45], v4 offset:38912
    ds_read_b64_tr_b16 v[46:47], v4 offset:39424
    ds_read_b128 v[60:63], v5 offset:38912
    s_waitcnt lgkmcnt(9)
    v_mfma_f32_32x32x16_bf16 v[16:31], v[32:35], v[48:51], v[16:31]
    s_waitcnt lgkmcnt(6)
    v_mfma_f32_32x32x16_bf16 v[16:31], v[36:39], v[52:55], v[16:31]
    s_waitcnt lgkmcnt(3)
    v_mfma_f32_32x32x16_bf16 v[16:31], v[40:43], v[56:59], v[16:31]
    s_waitcnt lgkmcnt(0)
    v_mfma_f32_32x32x16_bf16 v[16:31], v[44:47], v[60:63], v[16:31]
    s_waitcnt vmcnt(4)
    s_barrier
    s_add_u32 m0, s66, 32768
    s_nop 0
    buffer_load_dwordx4 v2, s[20:23], s62 offen lds
    s_add_u32 m0, s66, 33792
    s_nop 0
    buffer_load_dwordx4 v2, s[20:23], s63 offen lds
    s_add_u32 m0, s66, 40960
    s_nop 0
    buffer_load_dwordx4 v3, s[24:27], s64 offen lds
    s_add_u32 m0, s66, 41984
    s_nop 0
    buffer_load_dwordx4 v3, s[24:27], s65 offen lds
    s_add_u32 s62, s62, 229376
    s_add_u32 s63, s63, 229376
    s_add_u32 s64, s64, 0x10000
    s_add_u32 s65, s65, 0x10000
    ds_read_b64_tr_b16 v[32:33], v4 offset:0
    ds_read_b64_tr_b16 v[34:35], v4 offset:512
    ds_read_b128 v[48:51], v5 offset:0
    ds_read_b64_tr_b16 v[36:37], v4 offset:2048
    ds_read_b64_tr_b16 v[38:39], v4 offset:2560
    ds_read_b128 v[52:55], v5 offset:2048
    ds_read_b64_tr_b16 v[40:41], v4 offset:4096
    ds_read_b64_tr_b16 v[42:43], v4 offset:4608
    ds_read_b128 v[56:59], v5 offset:4096
    ds_read_b64_tr_b16 v[44:45], v4 offset:6144
    ds_read_b64_tr_b16 v[46:47], v4 offset:6656
    ds_read_b128 v[60:63], v5 offset:6144
    s_waitcnt lgkmcnt(9)
    v_mfma_f32_32x32x16_bf16 v[16:31], v[32:35], v[48:51], v[16:31]
    s_waitcnt lgkmcnt(6)
    v_mfma_f32_32x32x16_bf16 v[16:31], v[36:39], v[52:55], v[16:31]
    s_waitcnt lgkmcnt(3)
    v_mfma_f32_32x32x16_bf16 v[16:31], v[40:43], v[56:59], v[16:31]
    s_waitcnt lgkmcnt(0)
    v_mfma_f32_32x32x16_bf16 v[16:31], v[44:47], v[60:63], v[16:31]
    s_waitcnt vmcnt(4)
    s_barrier
    s_add_u32 m0, s66, 0
    s_nop 0
    buffer_load_dwordx4 v2, s[20:23], s62 offen lds
    s_add_u32 m0, s66, 1024
    s_nop 0
    buffer_load_dwordx4 v2, s[20:23], s63 offen lds
    s_add_u32 m0, s66, 8192
    s_nop 0
    buffer_load_dwordx4 v3, s[24:27], s64 offen lds
    s_add_u32 m0, s66, 9216
    s_nop 0
    buffer_load_dwordx4 v3, s[24:27], s65 offen lds
    s_add_u32 s62, s62, 229376
    s_add_u32 s63, s63, 229376
    s_add_u32 s64, s64, 0x10000
    s_add_u32 s65, s65, 0x10000
    ds_read_b64_tr_b16 v[32:33], v4 offset:16384
    ds_read_b64_tr_b16 v[34:35], v4 offset:16896
    ds_read_b128 v[48:51], v5 offset:16384
    ds_read_b64_tr_b16 v[36:37], v4 offset:18432
    ds_read_b64_tr_b16 v[38:39], v4 offset:18944
    ds_read_b128 v[52:55], v5 offset:18432
    ds_read_b64_tr_b16 v[40:41], v4 offset:20480
    ds_read_b64_tr_b16 v[42:43], v4 offset:20992
    ds_read_b128 v[56:59], v5 offset:20480
    ds_read_b64_tr_b16 v[44:45], v4 offset:22528
    ds_read_b64_tr_b16 v[46:47], v4 offset:23040
    ds_read_b128 v[60:63], v5 offset:22528
    s_waitcnt lgkmcnt(9)
    v_mfma_f32_32x32x16_bf16 v[16:31], v[32:35], v[48:51], v[16:31]
    s_waitcnt lgkmcnt(6)
    v_mfma_f32_32x32x16_bf16 v[16:31], v[36:39], v[52:55], v[16:31]
    s_waitcnt lgkmcnt(3)
    v_mfma_f32_32x32x16_bf16 v[16:31], v[40:43], v[56:59], v[16:31]
    s_waitcnt lgkmcnt(0)
    v_mfma_f32_32x32x16_bf16 v[16:31], v[44:47], v[60:63], v[16:31]
    s_waitcnt vmcnt(4)
    s_barrier
    s_add_u32 m0, s66, 16384
    s_nop 0
    buffer_load_dwordx4 v2, s[20:23], s62 offen lds
    s_add_u32 m0, s66, 17408
    s_nop 0
    buffer_load_dwordx4 v2, s[20:23], s63 offen lds
    s_add_u32 m0, s66, 24576
    s_nop 0
    buffer_load_dwordx4 v3, s[24:27], s64 offen lds
    s_add_u32 m0, s66, 25600
    s_nop 0
    buffer_load_dwordx4 v3, s[24:27], s65 offen lds
    s_add_u32 s62, s62, 229376
    s_add_u32 s63, s63, 229376
    s_add_u32 s64, s64, 0x10000
    s_add_u32 s65, s65, 0x10000
    ds_read_b64_tr_b16 v[32:33], v4 offset:32768
    ds_read_b64_tr_b16 v[34:35], v4 offset:33280
    ds_read_b128 v[48:51], v5 offset:32768
    ds_read_b64_tr_b16 v[36:37], v4 offset:34816
    ds_read_b64_tr_b16 v[38:39], v4 offset:35328
    ds_read_b128 v[52:55], v5 offset:34816
    ds_read_b64_tr_b16 v[40:41], v4 offset:36864
    ds_read_b64_tr_b16 v[42:43], v4 offset:37376
    ds_read_b128 v[56:59], v5 offset:36864
    ds_read_b64_tr_b16 v[44:45], v4 offset:38912
    ds_read_b64_tr_b16 v[46:47], v4 offset:39424
    ds_read_b128 v[60:63], v5 offset:38912
    s_waitcnt lgkmcnt(9)
    v_mfma_f32_32x32x16_bf16 v[16:31], v[32:35], v[48:51], v[16:31]
    s_waitcnt lgkmcnt(6)
    v_mfma_f32_32x32x16_bf16 v[16:31], v[36:39], v[52:55], v[16:31]
    s_waitcnt lgkmcnt(3)
    v_mfma_f32_32x32x16_bf16 v[16:31], v[40:43], v[56:59], v[16:31]
    s_waitcnt lgkmcnt(0)
    v_mfma_f32_32x32x16_bf16 v[16:31], v[44:47], v[60:63], v[16:31]
    s_waitcnt vmcnt(4)
    s_barrier
    s_add_u32 m0, s66, 32768
    s_nop 0
    buffer_load_dwordx4 v2, s[20:23], s62 offen lds
    s_add_u32 m0, s66, 33792
    s_nop 0
    buffer_load_dwordx4 v2, s[20:23], s63 offen lds
    s_add_u32 m0, s66, 40960
    s_nop 0
    buffer_load_dwordx4 v3, s[24:27], s64 offen lds
    s_add_u32 m0, s66, 41984
    s_nop 0
    buffer_load_dwordx4 v3, s[24:27], s65 offen lds
    s_add_u32 s62, s62, 229376
    s_add_u32 s63, s63, 229376
    s_add_u32 s64, s64, 0x10000
    s_add_u32 s65, s65, 0x10000
    ds_read_b64_tr_b16 v[32:33], v4 offset:0
    ds_read_b64_tr_b16 v[34:35], v4 offset:512
    ds_read_b128 v[48:51], v5 offset:0
    ds_read_b64_tr_b16 v[36:37], v4 offset:2048
    ds_read_b64_tr_b16 v[38:39], v4 offset:2560
    ds_read_b128 v[52:55], v5 offset:2048
    ds_read_b64_tr_b16 v[40:41], v4 offset:4096
    ds_read_b64_tr_b16 v[42:43], v4 offset:4608
    ds_read_b128 v[56:59], v5 offset:4096
    ds_read_b64_tr_b16 v[44:45], v4 offset:6144
    ds_read_b64_tr_b16 v[46:47], v4 offset:6656
    ds_read_b128 v[60:63], v5 offset:6144
    s_waitcnt lgkmcnt(9)
    v_mfma_f32_32x32x16_bf16 v[16:31], v[32:35], v[48:51], v[16:31]
    s_waitcnt lgkmcnt(6)
    v_mfma_f32_32x32x16_bf16 v[16:31], v[36:39], v[52:55], v[16:31]
    s_waitcnt lgkmcnt(3)
    v_mfma_f32_32x32x16_bf16 v[16:31], v[40:43], v[56:59], v[16:31]
    s_waitcnt lgkmcnt(0)
    v_mfma_f32_32x32x16_bf16 v[16:31], v[44:47], v[60:63], v[16:31]
    s_waitcnt vmcnt(4)
    s_barrier
    s_add_u32 m0, s66, 0
    s_nop 0
    buffer_load_dwordx4 v2, s[20:23], s62 offen lds
    s_add_u32 m0, s66, 1024
    s_nop 0
    buffer_load_dwordx4 v2, s[20:23], s63 offen lds
    s_add_u32 m0, s66, 8192
    s_nop 0
    buffer_load_dwordx4 v3, s[24:27], s64 offen lds
    s_add_u32 m0, s66, 9216
    s_nop 0
    buffer_load_dwordx4 v3, s[24:27], s65 offen lds
    s_add_u32 s62, s62, 229376
    s_add_u32 s63, s63, 229376
    s_add_u32 s64, s64, 0x10000
    s_add_u32 s65, s65, 0x10000
    ds_read_b64_tr_b16 v[32:33], v4 offset:16384
    ds_read_b64_tr_b16 v[34:35], v4 offset:16896
    ds_read_b128 v[48:51], v5 offset:16384
    ds_read_b64_tr_b16 v[36:37], v4 offset:18432
    ds_read_b64_tr_b16 v[38:39], v4 offset:18944
    ds_read_b128 v[52:55], v5 offset:18432
    ds_read_b64_tr_b16 v[40:41], v4 offset:20480
    ds_read_b64_tr_b16 v[42:43], v4 offset:20992
    ds_read_b128 v[56:59], v5 offset:20480
    ds_read_b64_tr_b16 v[44:45], v4 offset:22528
    ds_read_b64_tr_b16 v[46:47], v4 offset:23040
    ds_read_b128 v[60:63], v5 offset:22528
    s_waitcnt lgkmcnt(9)
    v_mfma_f32_32x32x16_bf16 v[16:31], v[32:35], v[48:51], v[16:31]
    s_waitcnt lgkmcnt(6)
    v_mfma_f32_32x32x16_bf16 v[16:31], v[36:39], v[52:55], v[16:31]
    s_waitcnt lgkmcnt(3)
    v_mfma_f32_32x32x16_bf16 v[16:31], v[40:43], v[56:59], v[16:31]
    s_waitcnt lgkmcnt(0)
    v_mfma_f32_32x32x16_bf16 v[16:31], v[44:47], v[60:63], v[16:31]
    s_waitcnt vmcnt(4)
    s_barrier
    s_add_u32 m0, s66, 16384
    s_nop 0
    buffer_load_dwordx4 v2, s[20:23], s62 offen lds
    s_add_u32 m0, s66, 17408
    s_nop 0
    buffer_load_dwordx4 v2, s[20:23], s63 offen lds
    s_add_u32 m0, s66, 24576
    s_nop 0
    buffer_load_dwordx4 v3, s[24:27], s64 offen lds
    s_add_u32 m0, s66, 25600
    s_nop 0
    buffer_load_dwordx4 v3, s[24:27], s65 offen lds
    s_add_u32 s62, s62, 229376
    s_add_u32 s63, s63, 229376
    s_add_u32 s64, s64, 0x10000
    s_add_u32 s65, s65, 0x10000
    ds_read_b64_tr_b16 v[32:33], v4 offset:32768
    ds_read_b64_tr_b16 v[34:35], v4 offset:33280
    ds_read_b128 v[48:51], v5 offset:32768
    ds_read_b64_tr_b16 v[36:37], v4 offset:34816
    ds_read_b64_tr_b16 v[38:39], v4 offset:35328
    ds_read_b128 v[52:55], v5 offset:34816
    ds_read_b64_tr_b16 v[40:41], v4 offset:36864
    ds_read_b64_tr_b16 v[42:43], v4 offset:37376
    ds_read_b128 v[56:59], v5 offset:36864
    ds_read_b64_tr_b16 v[44:45], v4 offset:38912
    ds_read_b64_tr_b16 v[46:47], v4 offset:39424
    ds_read_b128 v[60:63], v5 offset:38912
    s_waitcnt lgkmcnt(9)
    v_mfma_f32_32x32x16_bf16 v[16:31], v[32:35], v[48:51], v[16:31]
    s_waitcnt lgkmcnt(6)
    v_mfma_f32_32x32x16_bf16 v[16:31], v[36:39], v[52:55], v[16:31]
    s_waitcnt lgkmcnt(3)
    v_mfma_f32_32x32x16_bf16 v[16:31], v[40:43], v[56:59], v[16:31]
    s_waitcnt lgkmcnt(0)
    v_mfma_f32_32x32x16_bf16 v[16:31], v[44:47], v[60:63], v[16:31]
    s_waitcnt vmcnt(4)
    s_barrier
    s_add_u32 m0, s66, 32768
    s_nop 0
    buffer_load_dwordx4 v2, s[20:23], s62 offen lds
    s_add_u32 m0, s66, 33792
    s_nop 0
    buffer_load_dwordx4 v2, s[20:23], s63 offen lds
    s_add_u32 m0, s66, 40960
    s_nop 0
    buffer_load_dwordx4 v3, s[24:27], s64 offen lds
    s_add_u32 m0, s66, 41984
    s_nop 0
    buffer_load_dwordx4 v3, s[24:27], s65 offen lds
    s_add_u32 s62, s62, 229376
    s_add_u32 s63, s63, 229376
    s_add_u32 s64, s64, 0x10000
    s_add_u32 s65, s65, 0x10000
    ds_read_b64_tr_b16 v[32:33], v4 offset:0
    ds_read_b64_tr_b16 v[34:35], v4 offset:512
    ds_read_b128 v[48:51], v5 offset:0
    ds_read_b64_tr_b16 v[36:37], v4 offset:2048
    ds_read_b64_tr_b16 v[38:39], v4 offset:2560
    ds_read_b128 v[52:55], v5 offset:2048
    ds_read_b64_tr_b16 v[40:41], v4 offset:4096
    ds_read_b64_tr_b16 v[42:43], v4 offset:4608
    ds_read_b128 v[56:59], v5 offset:4096
    ds_read_b64_tr_b16 v[44:45], v4 offset:6144
    ds_read_b64_tr_b16 v[46:47], v4 offset:6656
    ds_read_b128 v[60:63], v5 offset:6144
    s_waitcnt lgkmcnt(9)
    v_mfma_f32_32x32x16_bf16 v[16:31], v[32:35], v[48:51], v[16:31]
    s_waitcnt lgkmcnt(6)
    v_mfma_f32_32x32x16_bf16 v[16:31], v[36:39], v[52:55], v[16:31]
    s_waitcnt lgkmcnt(3)
    v_mfma_f32_32x32x16_bf16 v[16:31], v[40:43], v[56:59], v[16:31]
    s_waitcnt lgkmcnt(0)
    v_mfma_f32_32x32x16_bf16 v[16:31], v[44:47], v[60:63], v[16:31]
    s_waitcnt vmcnt(4)
    s_barrier
    s_add_u32 m0, s66, 0
    s_nop 0
    buffer_load_dwordx4 v2, s[20:23], s62 offen lds
    s_add_u32 m0, s66, 1024
    s_nop 0
    buffer_load_dwordx4 v2, s[20:23], s63 offen lds
    s_add_u32 m0, s66, 8192
    s_nop 0
    buffer_load_dwordx4 v3, s[24:27], s64 offen lds
    s_add_u32 m0, s66, 9216
    s_nop 0
    buffer_load_dwordx4 v3, s[24:27], s65 offen lds
    s_add_u32 s62, s62, 229376
    s_add_u32 s63, s63, 229376
    s_add_u32 s64, s64, 0x10000
    s_add_u32 s65, s65, 0x10000
    ds_read_b64_tr_b16 v[32:33], v4 offset:16384
    ds_read_b64_tr_b16 v[34:35], v4 offset:16896
    ds_read_b128 v[48:51], v5 offset:16384
    ds_read_b64_tr_b16 v[36:37], v4 offset:18432
    ds_read_b64_tr_b16 v[38:39], v4 offset:18944
    ds_read_b128 v[52:55], v5 offset:18432
    ds_read_b64_tr_b16 v[40:41], v4 offset:20480
    ds_read_b64_tr_b16 v[42:43], v4 offset:20992
    ds_read_b128 v[56:59], v5 offset:20480
    ds_read_b64_tr_b16 v[44:45], v4 offset:22528
    ds_read_b64_tr_b16 v[46:47], v4 offset:23040
    ds_read_b128 v[60:63], v5 offset:22528
    s_waitcnt lgkmcnt(9)
    v_mfma_f32_32x32x16_bf16 v[16:31], v[32:35], v[48:51], v[16:31]
    s_waitcnt lgkmcnt(6)
    v_mfma_f32_32x32x16_bf16 v[16:31], v[36:39], v[52:55], v[16:31]
    s_waitcnt lgkmcnt(3)
    v_mfma_f32_32x32x16_bf16 v[16:31], v[40:43], v[56:59], v[16:31]
    s_waitcnt lgkmcnt(0)
    v_mfma_f32_32x32x16_bf16 v[16:31], v[44:47], v[60:63], v[16:31]
    s_waitcnt vmcnt(4)
    s_barrier
    s_add_u32 m0, s66, 16384
    s_nop 0
    buffer_load_dwordx4 v2, s[20:23], s62 offen lds
    s_add_u32 m0, s66, 17408
    s_nop 0
    buffer_load_dwordx4 v2, s[20:23], s63 offen lds
    s_add_u32 m0, s66, 24576
    s_nop 0
    buffer_load_dwordx4 v3, s[24:27], s64 offen lds
    s_add_u32 m0, s66, 25600
    s_nop 0
    buffer_load_dwordx4 v3, s[24:27], s65 offen lds
    s_add_u32 s62, s62, 229376
    s_add_u32 s63, s63, 229376
    s_add_u32 s64, s64, 0x10000
    s_add_u32 s65, s65, 0x10000
    ds_read_b64_tr_b16 v[32:33], v4 offset:32768
    ds_read_b64_tr_b16 v[34:35], v4 offset:33280
    ds_read_b128 v[48:51], v5 offset:32768
    ds_read_b64_tr_b16 v[36:37], v4 offset:34816
    ds_read_b64_tr_b16 v[38:39], v4 offset:35328
    ds_read_b128 v[52:55], v5 offset:34816
    ds_read_b64_tr_b16 v[40:41], v4 offset:36864
    ds_read_b64_tr_b16 v[42:43], v4 offset:37376
    ds_read_b128 v[56:59], v5 offset:36864
    ds_read_b64_tr_b16 v[44:45], v4 offset:38912
    ds_read_b64_tr_b16 v[46:47], v4 offset:39424
    ds_read_b128 v[60:63], v5 offset:38912
    s_waitcnt lgkmcnt(9)
    v_mfma_f32_32x32x16_bf16 v[16:31], v[32:35], v[48:51], v[16:31]
    s_waitcnt lgkmcnt(6)
    v_mfma_f32_32x32x16_bf16 v[16:31], v[36:39], v[52:55], v[16:31]
    s_waitcnt lgkmcnt(3)
    v_mfma_f32_32x32x16_bf16 v[16:31], v[40:43], v[56:59], v[16:31]
    s_waitcnt lgkmcnt(0)
    v_mfma_f32_32x32x16_bf16 v[16:31], v[44:47], v[60:63], v[16:31]
    s_waitcnt vmcnt(4)
    s_barrier
    s_add_u32 m0, s66, 32768
    s_nop 0
    buffer_load_dwordx4 v2, s[20:23], s62 offen lds
    s_add_u32 m0, s66, 33792
    s_nop 0
    buffer_load_dwordx4 v2, s[20:23], s63 offen lds
    s_add_u32 m0, s66, 40960
    s_nop 0
    buffer_load_dwordx4 v3, s[24:27], s64 offen lds
    s_add_u32 m0, s66, 41984
    s_nop 0
    buffer_load_dwordx4 v3, s[24:27], s65 offen lds
    s_add_u32 s62, s62, 229376
    s_add_u32 s63, s63, 229376
    s_add_u32 s64, s64, 0x10000
    s_add_u32 s65, s65, 0x10000
    ds_read_b64_tr_b16 v[32:33], v4 offset:0
    ds_read_b64_tr_b16 v[34:35], v4 offset:512
    ds_read_b128 v[48:51], v5 offset:0
    ds_read_b64_tr_b16 v[36:37], v4 offset:2048
    ds_read_b64_tr_b16 v[38:39], v4 offset:2560
    ds_read_b128 v[52:55], v5 offset:2048
    ds_read_b64_tr_b16 v[40:41], v4 offset:4096
    ds_read_b64_tr_b16 v[42:43], v4 offset:4608
    ds_read_b128 v[56:59], v5 offset:4096
    ds_read_b64_tr_b16 v[44:45], v4 offset:6144
    ds_read_b64_tr_b16 v[46:47], v4 offset:6656
    ds_read_b128 v[60:63], v5 offset:6144
    s_waitcnt lgkmcnt(9)
    v_mfma_f32_32x32x16_bf16 v[16:31], v[32:35], v[48:51], v[16:31]
    s_waitcnt lgkmcnt(6)
    v_mfma_f32_32x32x16_bf16 v[16:31], v[36:39], v[52:55], v[16:31]
    s_waitcnt lgkmcnt(3)
    v_mfma_f32_32x32x16_bf16 v[16:31], v[40:43], v[56:59], v[16:31]
    s_waitcnt lgkmcnt(0)
    v_mfma_f32_32x32x16_bf16 v[16:31], v[44:47], v[60:63], v[16:31]
    s_waitcnt vmcnt(4)
    s_barrier
    s_add_u32 m0, s66, 0
    s_nop 0
    buffer_load_dwordx4 v2, s[20:23], s62 offen lds
    s_add_u32 m0, s66, 1024
    s_nop 0
    buffer_load_dwordx4 v2, s[20:23], s63 offen lds
    s_add_u32 m0, s66, 8192
    s_nop 0
    buffer_load_dwordx4 v3, s[24:27], s64 offen lds
    s_add_u32 m0, s66, 9216
    s_nop 0
    buffer_load_dwordx4 v3, s[24:27], s65 offen lds
    s_add_u32 s62, s62, 229376
    s_add_u32 s63, s63, 229376
    s_add_u32 s64, s64, 0x10000
    s_add_u32 s65, s65, 0x10000
    ds_read_b64_tr_b16 v[32:33], v4 offset:16384
    ds_read_b64_tr_b16 v[34:35], v4 offset:16896
    ds_read_b128 v[48:51], v5 offset:16384
    ds_read_b64_tr_b16 v[36:37], v4 offset:18432
    ds_read_b64_tr_b16 v[38:39], v4 offset:18944
    ds_read_b128 v[52:55], v5 offset:18432
    ds_read_b64_tr_b16 v[40:41], v4 offset:20480
    ds_read_b64_tr_b16 v[42:43], v4 offset:20992
    ds_read_b128 v[56:59], v5 offset:20480
    ds_read_b64_tr_b16 v[44:45], v4 offset:22528
    ds_read_b64_tr_b16 v[46:47], v4 offset:23040
    ds_read_b128 v[60:63], v5 offset:22528
    s_waitcnt lgkmcnt(9)
    v_mfma_f32_32x32x16_bf16 v[16:31], v[32:35], v[48:51], v[16:31]
    s_waitcnt lgkmcnt(6)
    v_mfma_f32_32x32x16_bf16 v[16:31], v[36:39], v[52:55], v[16:31]
    s_waitcnt lgkmcnt(3)
    v_mfma_f32_32x32x16_bf16 v[16:31], v[40:43], v[56:59], v[16:31]
    s_waitcnt lgkmcnt(0)
    v_mfma_f32_32x32x16_bf16 v[16:31], v[44:47], v[60:63], v[16:31]
    s_waitcnt vmcnt(4)
    s_barrier
    s_add_u32 m0, s66, 16384
    s_nop 0
    buffer_load_dwordx4 v2, s[20:23], s62 offen lds
    s_add_u32 m0, s66, 17408
    s_nop 0
    buffer_load_dwordx4 v2, s[20:23], s63 offen lds
    s_add_u32 m0, s66, 24576
    s_nop 0
    buffer_load_dwordx4 v3, s[24:27], s64 offen lds
    s_add_u32 m0, s66, 25600
    s_nop 0
    buffer_load_dwordx4 v3, s[24:27], s65 offen lds
    s_add_u32 s62, s62, 229376
    s_add_u32 s63, s63, 229376
    s_add_u32 s64, s64, 0x10000
    s_add_u32 s65, s65, 0x10000
    ds_read_b64_tr_b16 v[32:33], v4 offset:32768
    ds_read_b64_tr_b16 v[34:35], v4 offset:33280
    ds_read_b128 v[48:51], v5 offset:32768
    ds_read_b64_tr_b16 v[36:37], v4 offset:34816
    ds_read_b64_tr_b16 v[38:39], v4 offset:35328
    ds_read_b128 v[52:55], v5 offset:34816
    ds_read_b64_tr_b16 v[40:41], v4 offset:36864
    ds_read_b64_tr_b16 v[42:43], v4 offset:37376
    ds_read_b128 v[56:59], v5 offset:36864
    ds_read_b64_tr_b16 v[44:45], v4 offset:38912
    ds_read_b64_tr_b16 v[46:47], v4 offset:39424
    ds_read_b128 v[60:63], v5 offset:38912
    s_waitcnt lgkmcnt(9)
    v_mfma_f32_32x32x16_bf16 v[16:31], v[32:35], v[48:51], v[16:31]
    s_waitcnt lgkmcnt(6)
    v_mfma_f32_32x32x16_bf16 v[16:31], v[36:39], v[52:55], v[16:31]
    s_waitcnt lgkmcnt(3)
    v_mfma_f32_32x32x16_bf16 v[16:31], v[40:43], v[56:59], v[16:31]
    s_waitcnt lgkmcnt(0)
    v_mfma_f32_32x32x16_bf16 v[16:31], v[44:47], v[60:63], v[16:31]
    s_waitcnt vmcnt(4)
    s_barrier
    s_add_u32 m0, s66, 32768
    s_nop 0
    buffer_load_dwordx4 v2, s[20:23], s62 offen lds
    s_add_u32 m0, s66, 33792
    s_nop 0
    buffer_load_dwordx4 v2, s[20:23], s63 offen lds
    s_add_u32 m0, s66, 40960
    s_nop 0
    buffer_load_dwordx4 v3, s[24:27], s64 offen lds
    s_add_u32 m0, s66, 41984
    s_nop 0
    buffer_load_dwordx4 v3, s[24:27], s65 offen lds
    s_add_u32 s62, s62, 229376
    s_add_u32 s63, s63, 229376
    s_add_u32 s64, s64, 0x10000
    s_add_u32 s65, s65, 0x10000
    ds_read_b64_tr_b16 v[32:33], v4 offset:0
    ds_read_b64_tr_b16 v[34:35], v4 offset:512
    ds_read_b128 v[48:51], v5 offset:0
    ds_read_b64_tr_b16 v[36:37], v4 offset:2048
    ds_read_b64_tr_b16 v[38:39], v4 offset:2560
    ds_read_b128 v[52:55], v5 offset:2048
    ds_read_b64_tr_b16 v[40:41], v4 offset:4096
    ds_read_b64_tr_b16 v[42:43], v4 offset:4608
    ds_read_b128 v[56:59], v5 offset:4096
    ds_read_b64_tr_b16 v[44:45], v4 offset:6144
    ds_read_b64_tr_b16 v[46:47], v4 offset:6656
    ds_read_b128 v[60:63], v5 offset:6144
    s_waitcnt lgkmcnt(9)
    v_mfma_f32_32x32x16_bf16 v[16:31], v[32:35], v[48:51], v[16:31]
    s_waitcnt lgkmcnt(6)
    v_mfma_f32_32x32x16_bf16 v[16:31], v[36:39], v[52:55], v[16:31]
    s_waitcnt lgkmcnt(3)
    v_mfma_f32_32x32x16_bf16 v[16:31], v[40:43], v[56:59], v[16:31]
    s_waitcnt lgkmcnt(0)
    v_mfma_f32_32x32x16_bf16 v[16:31], v[44:47], v[60:63], v[16:31]
    s_waitcnt vmcnt(4)
    s_barrier
    s_add_u32 m0, s66, 0
    s_nop 0
    buffer_load_dwordx4 v2, s[20:23], s62 offen lds
    s_add_u32 m0, s66, 1024
    s_nop 0
    buffer_load_dwordx4 v2, s[20:23], s63 offen lds
    s_add_u32 m0, s66, 8192
    s_nop 0
    buffer_load_dwordx4 v3, s[24:27], s64 offen lds
    s_add_u32 m0, s66, 9216
    s_nop 0
    buffer_load_dwordx4 v3, s[24:27], s65 offen lds
    s_add_u32 s62, s62, 229376
    s_add_u32 s63, s63, 229376
    s_add_u32 s64, s64, 0x10000
    s_add_u32 s65, s65, 0x10000
    ds_read_b64_tr_b16 v[32:33], v4 offset:16384
    ds_read_b64_tr_b16 v[34:35], v4 offset:16896
    ds_read_b128 v[48:51], v5 offset:16384
    ds_read_b64_tr_b16 v[36:37], v4 offset:18432
    ds_read_b64_tr_b16 v[38:39], v4 offset:18944
    ds_read_b128 v[52:55], v5 offset:18432
    ds_read_b64_tr_b16 v[40:41], v4 offset:20480
    ds_read_b64_tr_b16 v[42:43], v4 offset:20992
    ds_read_b128 v[56:59], v5 offset:20480
    ds_read_b64_tr_b16 v[44:45], v4 offset:22528
    ds_read_b64_tr_b16 v[46:47], v4 offset:23040
    ds_read_b128 v[60:63], v5 offset:22528
    s_waitcnt lgkmcnt(9)
    v_mfma_f32_32x32x16_bf16 v[16:31], v[32:35], v[48:51], v[16:31]
    s_waitcnt lgkmcnt(6)
    v_mfma_f32_32x32x16_bf16 v[16:31], v[36:39], v[52:55], v[16:31]
    s_waitcnt lgkmcnt(3)
    v_mfma_f32_32x32x16_bf16 v[16:31], v[40:43], v[56:59], v[16:31]
    s_waitcnt lgkmcnt(0)
    v_mfma_f32_32x32x16_bf16 v[16:31], v[44:47], v[60:63], v[16:31]
    s_waitcnt vmcnt(4)
    s_barrier
    s_add_u32 m0, s66, 16384
    s_nop 0
    buffer_load_dwordx4 v2, s[20:23], s62 offen lds
    s_add_u32 m0, s66, 17408
    s_nop 0
    buffer_load_dwordx4 v2, s[20:23], s63 offen lds
    s_add_u32 m0, s66, 24576
    s_nop 0
    buffer_load_dwordx4 v3, s[24:27], s64 offen lds
    s_add_u32 m0, s66, 25600
    s_nop 0
    buffer_load_dwordx4 v3, s[24:27], s65 offen lds
    s_add_u32 s62, s62, 229376
    s_add_u32 s63, s63, 229376
    s_add_u32 s64, s64, 0x10000
    s_add_u32 s65, s65, 0x10000
    ds_read_b64_tr_b16 v[32:33], v4 offset:32768
    ds_read_b64_tr_b16 v[34:35], v4 offset:33280
    ds_read_b128 v[48:51], v5 offset:32768
    ds_read_b64_tr_b16 v[36:37], v4 offset:34816
    ds_read_b64_tr_b16 v[38:39], v4 offset:35328
    ds_read_b128 v[52:55], v5 offset:34816
    ds_read_b64_tr_b16 v[40:41], v4 offset:36864
    ds_read_b64_tr_b16 v[42:43], v4 offset:37376
    ds_read_b128 v[56:59], v5 offset:36864
    ds_read_b64_tr_b16 v[44:45], v4 offset:38912
    ds_read_b64_tr_b16 v[46:47], v4 offset:39424
    ds_read_b128 v[60:63], v5 offset:38912
    s_waitcnt lgkmcnt(9)
    v_mfma_f32_32x32x16_bf16 v[16:31], v[32:35], v[48:51], v[16:31]
    s_waitcnt lgkmcnt(6)
    v_mfma_f32_32x32x16_bf16 v[16:31], v[36:39], v[52:55], v[16:31]
    s_waitcnt lgkmcnt(3)
    v_mfma_f32_32x32x16_bf16 v[16:31], v[40:43], v[56:59], v[16:31]
    s_waitcnt lgkmcnt(0)
    v_mfma_f32_32x32x16_bf16 v[16:31], v[44:47], v[60:63], v[16:31]
    s_waitcnt vmcnt(4)
    s_barrier
    ds_read_b64_tr_b16 v[32:33], v4 offset:0
    ds_read_b64_tr_b16 v[34:35], v4 offset:512
    ds_read_b128 v[48:51], v5 offset:0
    ds_read_b64_tr_b16 v[36:37], v4 offset:2048
    ds_read_b64_tr_b16 v[38:39], v4 offset:2560
    ds_read_b128 v[52:55], v5 offset:2048
    ds_read_b64_tr_b16 v[40:41], v4 offset:4096
    ds_read_b64_tr_b16 v[42:43], v4 offset:4608
    ds_read_b128 v[56:59], v5 offset:4096
    ds_read_b64_tr_b16 v[44:45], v4 offset:6144
    ds_read_b64_tr_b16 v[46:47], v4 offset:6656
    ds_read_b128 v[60:63], v5 offset:6144
    s_waitcnt lgkmcnt(9)
    v_mfma_f32_32x32x16_bf16 v[16:31], v[32:35], v[48:51], v[16:31]
    s_waitcnt lgkmcnt(6)
    v_mfma_f32_32x32x16_bf16 v[16:31], v[36:39], v[52:55], v[16:31]
    s_waitcnt lgkmcnt(3)
    v_mfma_f32_32x32x16_bf16 v[16:31], v[40:43], v[56:59], v[16:31]
    s_waitcnt lgkmcnt(0)
    v_mfma_f32_32x32x16_bf16 v[16:31], v[44:47], v[60:63], v[16:31]
    s_waitcnt vmcnt(0)
    s_barrier
    ds_read_b64_tr_b16 v[32:33], v4 offset:16384
    ds_read_b64_tr_b16 v[34:35], v4 offset:16896
    ds_read_b128 v[48:51], v5 offset:16384
    ds_read_b64_tr_b16 v[36:37], v4 offset:18432
    ds_read_b64_tr_b16 v[38:39], v4 offset:18944
    ds_read_b128 v[52:55], v5 offset:18432
    ds_read_b64_tr_b16 v[40:41], v4 offset:20480
    ds_read_b64_tr_b16 v[42:43], v4 offset:20992
    ds_read_b128 v[56:59], v5 offset:20480
    ds_read_b64_tr_b16 v[44:45], v4 offset:22528
    ds_read_b64_tr_b16 v[46:47], v4 offset:23040
    ds_read_b128 v[60:63], v5 offset:22528
    s_waitcnt lgkmcnt(9)
    v_mfma_f32_32x32x16_bf16 v[16:31], v[32:35], v[48:51], v[16:31]
    s_waitcnt lgkmcnt(6)
    v_mfma_f32_32x32x16_bf16 v[16:31], v[36:39], v[52:55], v[16:31]
    s_waitcnt lgkmcnt(3)
    v_mfma_f32_32x32x16_bf16 v[16:31], v[40:43], v[56:59], v[16:31]
    s_waitcnt lgkmcnt(0)
    v_mfma_f32_32x32x16_bf16 v[16:31], v[44:47], v[60:63], v[16:31]
    s_mov_b32 s68, 0xc01357a2
    s_mov_b32 s69, 0xbdd2d3e0
    v_and_b32 v6, 31, v0
    s_lshl_b32 s67, s61, 5
    v_add_u32 v6, s67, v6
    v_lshlrev_b32 v6, 4, v6
    v_lshrrev_b32 v7, 5, v0
    v_lshlrev_b32 v7, 3, v7
    v_add_u32 v6, v6, v7
    s_lshl_b32 s67, s60, 15
    v_add_u32 v6, s67, v6
    s_lshl_b32 s67, s14, 16
    s_lshl_b32 s70, s15, 10
    s_add_u32 s67, s67, s70
    v_cvt_pk_bf16_f32 v8, v16, v17
    v_lshlrev_b32 v9, 16, v8
    v_and_b32 v10, 0xffff0000, v8
    v_lshlrev_b32 v11, 16, v64
    v_and_b32 v12, 0xffff0000, v64
    v_add_f32 v9, v9, v11
    v_add_f32 v10, v10, v12
    v_cvt_pk_bf16_f32 v8, v9, v10
    v_lshlrev_b32 v9, 16, v8
    v_and_b32 v10, 0xffff0000, v8
    v_mul_f32 v11, v9, v9
    v_mov_b32 v13, s68
    v_fmac_f32 v13, s69, v11
    v_mul_f32 v13, v13, v9
    v_exp_f32 v13, v13
    s_nop 0
    v_add_f32 v13, 1.0, v13
    v_rcp_f32 v13, v13
    s_nop 0
    v_mul_f32 v9, v9, v13
    v_mul_f32 v11, v10, v10
    v_mov_b32 v13, s68
    v_fmac_f32 v13, s69, v11
    v_mul_f32 v13, v13, v10
    v_exp_f32 v13, v13
    s_nop 0
    v_add_f32 v13, 1.0, v13
    v_rcp_f32 v13, v13
    s_nop 0
    v_mul_f32 v10, v10, v13
    v_cvt_pk_bf16_f32 v72, v9, v10
    v_cvt_pk_bf16_f32 v8, v18, v19
    v_lshlrev_b32 v9, 16, v8
    v_and_b32 v10, 0xffff0000, v8
    v_lshlrev_b32 v11, 16, v65
    v_and_b32 v12, 0xffff0000, v65
    v_add_f32 v9, v9, v11
    v_add_f32 v10, v10, v12
    v_cvt_pk_bf16_f32 v8, v9, v10
    v_lshlrev_b32 v9, 16, v8
    v_and_b32 v10, 0xffff0000, v8
    v_mul_f32 v11, v9, v9
    v_mov_b32 v13, s68
    v_fmac_f32 v13, s69, v11
    v_mul_f32 v13, v13, v9
    v_exp_f32 v13, v13
    s_nop 0
    v_add_f32 v13, 1.0, v13
    v_rcp_f32 v13, v13
    s_nop 0
    v_mul_f32 v9, v9, v13
    v_mul_f32 v11, v10, v10
    v_mov_b32 v13, s68
    v_fmac_f32 v13, s69, v11
    v_mul_f32 v13, v13, v10
    v_exp_f32 v13, v13
    s_nop 0
    v_add_f32 v13, 1.0, v13
    v_rcp_f32 v13, v13
    s_nop 0
    v_mul_f32 v10, v10, v13
    v_cvt_pk_bf16_f32 v73, v9, v10
    buffer_store_dwordx2 v[72:73], v6, s[32:35], s67 offen offset:0
    s_add_u32 s71, s67, 8192
    v_cvt_pk_bf16_f32 v8, v20, v21
    v_lshlrev_b32 v9, 16, v8
    v_and_b32 v10, 0xffff0000, v8
    v_lshlrev_b32 v11, 16, v66
    v_and_b32 v12, 0xffff0000, v66
    v_add_f32 v9, v9, v11
    v_add_f32 v10, v10, v12
    v_cvt_pk_bf16_f32 v8, v9, v10
    v_lshlrev_b32 v9, 16, v8
    v_and_b32 v10, 0xffff0000, v8
    v_mul_f32 v11, v9, v9
    v_mov_b32 v13, s68
    v_fmac_f32 v13, s69, v11
    v_mul_f32 v13, v13, v9
    v_exp_f32 v13, v13
    s_nop 0
    v_add_f32 v13, 1.0, v13
    v_rcp_f32 v13, v13
    s_nop 0
    v_mul_f32 v9, v9, v13
    v_mul_f32 v11, v10, v10
    v_mov_b32 v13, s68
    v_fmac_f32 v13, s69, v11
    v_mul_f32 v13, v13, v10
    v_exp_f32 v13, v13
    s_nop 0
    v_add_f32 v13, 1.0, v13
    v_rcp_f32 v13, v13
    s_nop 0
    v_mul_f32 v10, v10, v13
    v_cvt_pk_bf16_f32 v72, v9, v10
    v_cvt_pk_bf16_f32 v8, v22, v23
    v_lshlrev_b32 v9, 16, v8
    v_and_b32 v10, 0xffff0000, v8
    v_lshlrev_b32 v11, 16, v67
    v_and_b32 v12, 0xffff0000, v67
    v_add_f32 v9, v9, v11
    v_add_f32 v10, v10, v12
    v_cvt_pk_bf16_f32 v8, v9, v10
    v_lshlrev_b32 v9, 16, v8
    v_and_b32 v10, 0xffff0000, v8
    v_mul_f32 v11, v9, v9
    v_mov_b32 v13, s68
    v_fmac_f32 v13, s69, v11
    v_mul_f32 v13, v13, v9
    v_exp_f32 v13, v13
    s_nop 0
    v_add_f32 v13, 1.0, v13
    v_rcp_f32 v13, v13
    s_nop 0
    v_mul_f32 v9, v9, v13
    v_mul_f32 v11, v10, v10
    v_mov_b32 v13, s68
    v_fmac_f32 v13, s69, v11
    v_mul_f32 v13, v13, v10
    v_exp_f32 v13, v13
    s_nop 0
    v_add_f32 v13, 1.0, v13
    v_rcp_f32 v13, v13
    s_nop 0
    v_mul_f32 v10, v10, v13
    v_cvt_pk_bf16_f32 v73, v9, v10
    buffer_store_dwordx2 v[72:73], v6, s[32:35], s71 offen
    s_add_u32 s71, s67, 16384
    v_cvt_pk_bf16_f32 v8, v24, v25
    v_lshlrev_b32 v9, 16, v8
    v_and_b32 v10, 0xffff0000, v8
    v_lshlrev_b32 v11, 16, v68
    v_and_b32 v12, 0xffff0000, v68
    v_add_f32 v9, v9, v11
    v_add_f32 v10, v10, v12
    v_cvt_pk_bf16_f32 v8, v9, v10
    v_lshlrev_b32 v9, 16, v8
    v_and_b32 v10, 0xffff0000, v8
    v_mul_f32 v11, v9, v9
    v_mov_b32 v13, s68
    v_fmac_f32 v13, s69, v11
    v_mul_f32 v13, v13, v9
    v_exp_f32 v13, v13
    s_nop 0
    v_add_f32 v13, 1.0, v13
    v_rcp_f32 v13, v13
    s_nop 0
    v_mul_f32 v9, v9, v13
    v_mul_f32 v11, v10, v10
    v_mov_b32 v13, s68
    v_fmac_f32 v13, s69, v11
    v_mul_f32 v13, v13, v10
    v_exp_f32 v13, v13
    s_nop 0
    v_add_f32 v13, 1.0, v13
    v_rcp_f32 v13, v13
    s_nop 0
    v_mul_f32 v10, v10, v13
    v_cvt_pk_bf16_f32 v72, v9, v10
    v_cvt_pk_bf16_f32 v8, v26, v27
    v_lshlrev_b32 v9, 16, v8
    v_and_b32 v10, 0xffff0000, v8
    v_lshlrev_b32 v11, 16, v69
    v_and_b32 v12, 0xffff0000, v69
    v_add_f32 v9, v9, v11
    v_add_f32 v10, v10, v12
    v_cvt_pk_bf16_f32 v8, v9, v10
    v_lshlrev_b32 v9, 16, v8
    v_and_b32 v10, 0xffff0000, v8
    v_mul_f32 v11, v9, v9
    v_mov_b32 v13, s68
    v_fmac_f32 v13, s69, v11
    v_mul_f32 v13, v13, v9
    v_exp_f32 v13, v13
    s_nop 0
    v_add_f32 v13, 1.0, v13
    v_rcp_f32 v13, v13
    s_nop 0
    v_mul_f32 v9, v9, v13
    v_mul_f32 v11, v10, v10
    v_mov_b32 v13, s68
    v_fmac_f32 v13, s69, v11
    v_mul_f32 v13, v13, v10
    v_exp_f32 v13, v13
    s_nop 0
    v_add_f32 v13, 1.0, v13
    v_rcp_f32 v13, v13
    s_nop 0
    v_mul_f32 v10, v10, v13
    v_cvt_pk_bf16_f32 v73, v9, v10
    buffer_store_dwordx2 v[72:73], v6, s[32:35], s71 offen
    s_add_u32 s71, s67, 24576
    v_cvt_pk_bf16_f32 v8, v28, v29
    v_lshlrev_b32 v9, 16, v8
    v_and_b32 v10, 0xffff0000, v8
    v_lshlrev_b32 v11, 16, v70
    v_and_b32 v12, 0xffff0000, v70
    v_add_f32 v9, v9, v11
    v_add_f32 v10, v10, v12
    v_cvt_pk_bf16_f32 v8, v9, v10
    v_lshlrev_b32 v9, 16, v8
    v_and_b32 v10, 0xffff0000, v8
    v_mul_f32 v11, v9, v9
    v_mov_b32 v13, s68
    v_fmac_f32 v13, s69, v11
    v_mul_f32 v13, v13, v9
    v_exp_f32 v13, v13
    s_nop 0
    v_add_f32 v13, 1.0, v13
    v_rcp_f32 v13, v13
    s_nop 0
    v_mul_f32 v9, v9, v13
    v_mul_f32 v11, v10, v10
    v_mov_b32 v13, s68
    v_fmac_f32 v13, s69, v11
    v_mul_f32 v13, v13, v10
    v_exp_f32 v13, v13
    s_nop 0
    v_add_f32 v13, 1.0, v13
    v_rcp_f32 v13, v13
    s_nop 0
    v_mul_f32 v10, v10, v13
    v_cvt_pk_bf16_f32 v72, v9, v10
    v_cvt_pk_bf16_f32 v8, v30, v31
    v_lshlrev_b32 v9, 16, v8
    v_and_b32 v10, 0xffff0000, v8
    v_lshlrev_b32 v11, 16, v71
    v_and_b32 v12, 0xffff0000, v71
    v_add_f32 v9, v9, v11
    v_add_f32 v10, v10, v12
    v_cvt_pk_bf16_f32 v8, v9, v10
    v_lshlrev_b32 v9, 16, v8
    v_and_b32 v10, 0xffff0000, v8
    v_mul_f32 v11, v9, v9
    v_mov_b32 v13, s68
    v_fmac_f32 v13, s69, v11
    v_mul_f32 v13, v13, v9
    v_exp_f32 v13, v13
    s_nop 0
    v_add_f32 v13, 1.0, v13
    v_rcp_f32 v13, v13
    s_nop 0
    v_mul_f32 v9, v9, v13
    v_mul_f32 v11, v10, v10
    v_mov_b32 v13, s68
    v_fmac_f32 v13, s69, v11
    v_mul_f32 v13, v13, v10
    v_exp_f32 v13, v13
    s_nop 0
    v_add_f32 v13, 1.0, v13
    v_rcp_f32 v13, v13
    s_nop 0
    v_mul_f32 v10, v10, v13
    v_cvt_pk_bf16_f32 v73, v9, v10
    buffer_store_dwordx2 v[72:73], v6, s[32:35], s71 offen
    s_add_u32 s71, s67, 32768
    s_endpgm
k1_conv:
    s_load_dwordx2 s[62:63], s[0:1], 8
    s_load_dwordx2 s[64:65], s[0:1], 16
    s_load_dwordx2 s[66:67], s[0:1], 24
    s_load_dwordx2 s[68:69], s[0:1], 32
    s_load_dwordx2 s[70:71], s[0:1], 40
    s_sub_u32 s40, s2, 224
    s_and_b32 s41, s40, 7
    s_lshl_b32 s41, s41, 3
    s_lshr_b32 s42, s40, 3
    s_and_b32 s42, s42, 7
    s_and_b32 s43, s40, 0x1c0
    s_add_u32 s40, s43, s41
    s_add_u32 s40, s40, s42
    s_waitcnt lgkmcnt(0)
    s_mov_b32 s20, s62
    s_and_b32 s21, s63, 0xffff
    s_mov_b32 s22, 0x20000
    s_mov_b32 s23, 0x00020000
    s_mov_b32 s24, s64
    s_and_b32 s25, s65, 0xffff
    s_mov_b32 s26, 0x20000
    s_mov_b32 s27, 0x00020000
    s_mov_b32 s28, s66
    s_and_b32 s29, s67, 0xffff
    s_mov_b32 s30, 0x20000
    s_mov_b32 s31, 0x00020000
    s_mov_b32 s32, s68
    s_and_b32 s33, s69, 0xffff
    s_mov_b32 s34, 0x20000
    s_mov_b32 s35, 0x00020000
    s_mov_b32 s36, s70
    s_and_b32 s37, s71, 0xffff
    s_mov_b32 s38, 0x400
    s_mov_b32 s39, 0x00020000
    s_mov_b32 s44, s8
    s_and_b32 s45, s9, 0xffff
    s_mov_b32 s46, 0x200000
    s_mov_b32 s47, 0x00020000
    s_add_u32 s48, s8, 0x200000
    s_addc_u32 s49, s9, 0
    s_and_b32 s49, s49, 0xffff
    s_mov_b32 s50, 0x200000
    s_mov_b32 s51, 0x00020000
    s_mov_b32 s72, s10
    s_and_b32 s73, s11, 0xffff
    s_mov_b32 s74, 0x400
    s_mov_b32 s75, 0x00020000
    s_add_u32 s76, s8, 0xb00000
    s_addc_u32 s77, s9, 0
    s_and_b32 s77, s77, 0xffff
    s_mov_b32 s78, 0x200000
    s_mov_b32 s79, 0x00020000
    s_lshl_b32 s41, s40, 4
    v_lshlrev_b32 v2, 13, v127
    v_add_u32 v3, 0xffffe000, v2
    buffer_load_dwordx4 v[160:163], v2, s[48:51], s41 offen
    buffer_load_dwordx4 v[164:167], v3, s[48:51], s41 offen
    s_lshl_b32 s41, s40, 8
    s_lshl_b32 s42, s40, 1
    v_lshrrev_b32 v2, 4, v0
    v_lshlrev_b32 v3, 4, v2
    s_lshl_b32 s43, s3, 6
    v_add_u32 v3, s43, v3
    v_lshlrev_b32 v4, 2, v0
    v_mov_b32 v5, 0
    buffer_load_dwordx4 v[8:11], v3, s[20:23], s41 offen
    buffer_load_dwordx4 v[12:15], v3, s[24:27], s41 offen
    buffer_load_dwordx4 v[16:19], v3, s[28:31], s41 offen
    buffer_load_dwordx4 v[20:23], v3, s[32:35], s41 offen
    buffer_load_dword v24, v4, s[28:31], s41 offen
    buffer_load_dword v25, v4, s[32:35], s41 offen
    buffer_load_ushort v26, v5, s[36:39], s42 offen
    v_and_b32 v6, 15, v0
    v_cvt_f32_u32 v7, v6
    v_lshlrev_b32 v27, 4, v6
    v_add_u32 v27, 1, v27
    v_cvt_f32_u32 v27, v27
    s_mov_b32 s52, 0x3fb8aa3b
    s_mov_b32 s53, 0x3e22f983
    s_waitcnt vmcnt(0)
    v_lshlrev_b32 v26, 16, v26
    v_mul_f32 v26, s52, v26
    v_exp_f32 v26, v26
    s_nop 0
    v_cvt_pk_bf16_f32 v28, v26, v26
    v_lshlrev_b32 v26, 16, v28
    v_lshlrev_b32 v28, 16, v24
    v_and_b32 v29, 0xffff0000, v24
    v_lshlrev_b32 v30, 16, v25
    v_and_b32 v31, 0xffff0000, v25
    v_add_f32 v32, v28, v29
    v_max_f32 v33, abs(v28), abs(v29)
    v_max_f32 v34, abs(v30), abs(v31)
    v_max_f32 v33, v33, v34
    v_add_f32_dpp v32, v32, v32 quad_perm:[1,0,3,2] row_mask:0xf bank_mask:0xf
    s_nop 1
    v_add_f32_dpp v32, v32, v32 quad_perm:[2,3,0,1] row_mask:0xf bank_mask:0xf
    s_nop 1
    v_add_f32_dpp v32, v32, v32 row_half_mirror row_mask:0xf bank_mask:0xf
    s_nop 1
    v_add_f32_dpp v32, v32, v32 row_mirror row_mask:0xf bank_mask:0xf
    s_nop 1
    v_add_f32_dpp v32, v32, v32 row_bcast:15 row_mask:0xa bank_mask:0xf
    s_nop 1
    v_add_f32_dpp v32, v32, v32 row_bcast:31 row_mask:0xc bank_mask:0xf
    v_max_f32_dpp v33, v33, v33 quad_perm:[1,0,3,2] row_mask:0xf bank_mask:0xf
    s_nop 1
    v_max_f32_dpp v33, v33, v33 quad_perm:[2,3,0,1] row_mask:0xf bank_mask:0xf
    s_nop 1
    v_max_f32_dpp v33, v33, v33 row_half_mirror row_mask:0xf bank_mask:0xf
    s_nop 1
    v_max_f32_dpp v33, v33, v33 row_mirror row_mask:0xf bank_mask:0xf
    s_nop 1
    v_max_f32_dpp v33, v33, v33 row_bcast:15 row_mask:0xa bank_mask:0xf
    s_nop 1
    v_max_f32_dpp v33, v33, v33 row_bcast:31 row_mask:0xc bank_mask:0xf
    v_readlane_b32 s54, v32, 63
    v_readlane_b32 s55, v33, 63
    s_nop 1
    v_mul_f32 v33, s55, v26
    v_mul_f32 v32, s54, v26
    v_add_f32 v32, v32, v32
    v_lshrrev_b32 v34, 23, v33
    v_and_b32 v34, 0xff, v34
    v_max_u32 v34, 14, v34
    v_min_u32 v34, 0xfd, v34
    v_sub_u32 v35, 0x10b, v34
    v_lshlrev_b32 v35, 23, v35
    v_add_u32 v36, -13, v34
    v_lshlrev_b32 v36, 23, v36
    v_mul_f32 v37, v26, v35
    v_lshlrev_b32 v40, 16, v8
    v_lshlrev_b32 v48, 16, v12
    v_lshlrev_b32 v56, 16, v16
    v_lshlrev_b32 v64, 16, v20
    v_and_b32 v41, 0xffff0000, v8
    v_and_b32 v49, 0xffff0000, v12
    v_and_b32 v57, 0xffff0000, v16
    v_and_b32 v65, 0xffff0000, v20
    v_lshlrev_b32 v42, 16, v9
    v_lshlrev_b32 v50, 16, v13
    v_lshlrev_b32 v58, 16, v17
    v_lshlrev_b32 v66, 16, v21
    v_and_b32 v43, 0xffff0000, v9
    v_and_b32 v51, 0xffff0000, v13
    v_and_b32 v59, 0xffff0000, v17
    v_and_b32 v67, 0xffff0000, v21
    v_lshlrev_b32 v44, 16, v10
    v_lshlrev_b32 v52, 16, v14
    v_lshlrev_b32 v60, 16, v18
    v_lshlrev_b32 v68, 16, v22
    v_and_b32 v45, 0xffff0000, v10
    v_and_b32 v53, 0xffff0000, v14
    v_and_b32 v61, 0xffff0000, v18
    v_and_b32 v69, 0xffff0000, v22
    v_lshlrev_b32 v46, 16, v11
    v_lshlrev_b32 v54, 16, v15
    v_lshlrev_b32 v62, 16, v19
    v_lshlrev_b32 v70, 16, v23
    v_and_b32 v47, 0xffff0000, v11
    v_and_b32 v55, 0xffff0000, v15
    v_and_b32 v63, 0xffff0000, v19
    v_and_b32 v71, 0xffff0000, v23
    v_mul_f32 v40, s52, v40
    v_exp_f32 v40, v40
    v_mul_f32 v41, s52, v41
    v_exp_f32 v41, v41
    v_mul_f32 v42, s52, v42
    v_exp_f32 v42, v42
    v_mul_f32 v43, s52, v43
    v_exp_f32 v43, v43
    v_mul_f32 v44, s52, v44
    v_exp_f32 v44, v44
    v_mul_f32 v45, s52, v45
    v_exp_f32 v45, v45
    v_mul_f32 v46, s52, v46
    v_exp_f32 v46, v46
    v_mul_f32 v47, s52, v47
    v_exp_f32 v47, v47
    v_cvt_pk_bf16_f32 v38, v40, v40
    v_lshlrev_b32 v40, 16, v38
    v_mul_f32 v40, v40, v26
    v_mul_f32 v40, s52, v40
    v_sub_f32 v40, 0, v40
    v_mul_f32 v48, v48, v26
    v_mul_f32 v48, s53, v48
    v_mul_f32 v56, v56, v37
    v_mul_f32 v64, v64, v37
    v_cvt_pk_bf16_f32 v38, v41, v41
    v_lshlrev_b32 v41, 16, v38
    v_mul_f32 v41, v41, v26
    v_mul_f32 v41, s52, v41
    v_sub_f32 v41, 0, v41
    v_mul_f32 v49, v49, v26
    v_mul_f32 v49, s53, v49
    v_mul_f32 v57, v57, v37
    v_mul_f32 v65, v65, v37
    v_cvt_pk_bf16_f32 v38, v42, v42
    v_lshlrev_b32 v42, 16, v38
    v_mul_f32 v42, v42, v26
    v_mul_f32 v42, s52, v42
    v_sub_f32 v42, 0, v42
    v_mul_f32 v50, v50, v26
    v_mul_f32 v50, s53, v50
    v_mul_f32 v58, v58, v37
    v_mul_f32 v66, v66, v37
    v_cvt_pk_bf16_f32 v38, v43, v43
    v_lshlrev_b32 v43, 16, v38
    v_mul_f32 v43, v43, v26
    v_mul_f32 v43, s52, v43
    v_sub_f32 v43, 0, v43
    v_mul_f32 v51, v51, v26
    v_mul_f32 v51, s53, v51
    v_mul_f32 v59, v59, v37
    v_mul_f32 v67, v67, v37
    v_cvt_pk_bf16_f32 v38, v44, v44
    v_lshlrev_b32 v44, 16, v38
    v_mul_f32 v44, v44, v26
    v_mul_f32 v44, s52, v44
    v_sub_f32 v44, 0, v44
    v_mul_f32 v52, v52, v26
    v_mul_f32 v52, s53, v52
    v_mul_f32 v60, v60, v37
    v_mul_f32 v68, v68, v37
    v_cvt_pk_bf16_f32 v38, v45, v45
    v_lshlrev_b32 v45, 16, v38
    v_mul_f32 v45, v45, v26
    v_mul_f32 v45, s52, v45
    v_sub_f32 v45, 0, v45
    v_mul_f32 v53, v53, v26
    v_mul_f32 v53, s53, v53
    v_mul_f32 v61, v61, v37
    v_mul_f32 v69, v69, v37
    v_cvt_pk_bf16_f32 v38, v46, v46
    v_lshlrev_b32 v46, 16, v38
    v_mul_f32 v46, v46, v26
    v_mul_f32 v46, s52, v46
    v_sub_f32 v46, 0, v46
    v_mul_f32 v54, v54, v26
    v_mul_f32 v54, s53, v54
    v_mul_f32 v62, v62, v37
    v_mul_f32 v70, v70, v37
    v_cvt_pk_bf16_f32 v38, v47, v47
    v_lshlrev_b32 v47, 16, v38
    v_mul_f32 v47, v47, v26
    v_mul_f32 v47, s52, v47
    v_sub_f32 v47, 0, v47
    v_mul_f32 v55, v55, v26
    v_mul_f32 v55, s53, v55
    v_mul_f32 v63, v63, v37
    v_mul_f32 v71, v71, v37
    v_pk_mul_f32 v[144:145], v[40:41], v[6:7] op_sel:[0,1] op_sel_hi:[1,1]
    v_pk_mul_f32 v[146:147], v[48:49], v[6:7] op_sel:[0,1] op_sel_hi:[1,1]
    v_exp_f32 v144, v144
    v_fract_f32 v146, v146
    v_exp_f32 v145, v145
    v_fract_f32 v147, v147
    v_cos_f32 v148, v146
    v_sin_f32 v146, v146
    v_cos_f32 v149, v147
    v_sin_f32 v147, v147
    v_pk_mul_f32 v[136:137], v[144:145], v[148:149]
    v_pk_mul_f32 v[138:139], v[144:145], v[146:147]
    v_pk_mul_f32 v[144:145], v[40:41], v[26:27] op_sel:[0,1] op_sel_hi:[1,1]
    v_pk_mul_f32 v[146:147], v[48:49], v[26:27] op_sel:[0,1] op_sel_hi:[1,1]
    v_exp_f32 v144, v144
    v_fract_f32 v146, v146
    v_exp_f32 v145, v145
    v_fract_f32 v147, v147
    v_cos_f32 v148, v146
    v_sin_f32 v146, v146
    v_cos_f32 v149, v147
    v_sin_f32 v147, v147
    v_pk_mul_f32 v[140:141], v[144:145], v[148:149]
    v_pk_mul_f32 v[142:143], v[144:145], v[146:147]
    v_pk_mul_f32 v[150:151], v[56:57], v[140:141]
    v_pk_mul_f32 v[152:153], v[56:57], v[142:143]
    v_pk_fma_f32 v[150:151], v[64:65], v[142:143], v[150:151] neg_lo:[1,0,0] neg_hi:[1,0,0]
    v_pk_fma_f32 v[152:153], v[64:65], v[140:141], v[152:153]
    v_cvt_pk_f16_f32 v80, v136, v137
    v_cvt_pk_f16_f32 v84, v138, v139
    v_cvt_pk_f16_f32 v72, v150, v151
    v_cvt_pk_f16_f32 v76, -v152, -v153
    v_pk_mul_f32 v[154:155], v[136:137], v[138:139]
    v_pk_mul_f32 v[156:157], v[138:139], v[138:139]
    v_pk_fma_f32 v[136:137], v[136:137], v[136:137], v[156:157] neg_lo:[0,0,1] neg_hi:[0,0,1]
    v_pk_add_f32 v[138:139], v[154:155], v[154:155]
    v_pk_mul_f32 v[154:155], v[140:141], v[142:143]
    v_pk_mul_f32 v[156:157], v[142:143], v[142:143]
    v_pk_fma_f32 v[140:141], v[140:141], v[140:141], v[156:157] neg_lo:[0,0,1] neg_hi:[0,0,1]
    v_pk_add_f32 v[142:143], v[154:155], v[154:155]
    v_pk_mul_f32 v[150:151], v[56:57], v[140:141]
    v_pk_mul_f32 v[152:153], v[56:57], v[142:143]
    v_pk_fma_f32 v[150:151], v[64:65], v[142:143], v[150:151] neg_lo:[1,0,0] neg_hi:[1,0,0]
    v_pk_fma_f32 v[152:153], v[64:65], v[140:141], v[152:153]
    v_cvt_pk_f16_f32 v96, v136, v137
    v_cvt_pk_f16_f32 v100, v138, v139
    v_cvt_pk_f16_f32 v88, v150, v151
    v_cvt_pk_f16_f32 v92, -v152, -v153
    v_pk_mul_f32 v[154:155], v[136:137], v[138:139]
    v_pk_mul_f32 v[156:157], v[138:139], v[138:139]
    v_pk_fma_f32 v[136:137], v[136:137], v[136:137], v[156:157] neg_lo:[0,0,1] neg_hi:[0,0,1]
    v_pk_add_f32 v[138:139], v[154:155], v[154:155]
    v_pk_mul_f32 v[154:155], v[140:141], v[142:143]
    v_pk_mul_f32 v[156:157], v[142:143], v[142:143]
    v_pk_fma_f32 v[140:141], v[140:141], v[140:141], v[156:157] neg_lo:[0,0,1] neg_hi:[0,0,1]
    v_pk_add_f32 v[142:143], v[154:155], v[154:155]
    v_pk_mul_f32 v[150:151], v[56:57], v[140:141]
    v_pk_mul_f32 v[152:153], v[56:57], v[142:143]
    v_pk_fma_f32 v[150:151], v[64:65], v[142:143], v[150:151] neg_lo:[1,0,0] neg_hi:[1,0,0]
    v_pk_fma_f32 v[152:153], v[64:65], v[140:141], v[152:153]
    v_cvt_pk_f16_f32 v112, v136, v137
    v_cvt_pk_f16_f32 v116, v138, v139
    v_cvt_pk_f16_f32 v104, v150, v151
    v_cvt_pk_f16_f32 v108, -v152, -v153
    v_pk_mul_f32 v[154:155], v[136:137], v[138:139]
    v_pk_mul_f32 v[156:157], v[138:139], v[138:139]
    v_pk_fma_f32 v[136:137], v[136:137], v[136:137], v[156:157] neg_lo:[0,0,1] neg_hi:[0,0,1]
    v_pk_add_f32 v[138:139], v[154:155], v[154:155]
    v_pk_mul_f32 v[154:155], v[140:141], v[142:143]
    v_pk_mul_f32 v[156:157], v[142:143], v[142:143]
    v_pk_fma_f32 v[140:141], v[140:141], v[140:141], v[156:157] neg_lo:[0,0,1] neg_hi:[0,0,1]
    v_pk_add_f32 v[142:143], v[154:155], v[154:155]
    v_pk_mul_f32 v[150:151], v[56:57], v[140:141]
    v_pk_mul_f32 v[152:153], v[56:57], v[142:143]
    v_pk_fma_f32 v[150:151], v[64:65], v[142:143], v[150:151] neg_lo:[1,0,0] neg_hi:[1,0,0]
    v_pk_fma_f32 v[152:153], v[64:65], v[140:141], v[152:153]
    v_cvt_pk_f16_f32 v128, v136, v137
    v_cvt_pk_f16_f32 v132, v138, v139
    v_cvt_pk_f16_f32 v120, v150, v151
    v_cvt_pk_f16_f32 v124, -v152, -v153
    v_pk_mul_f32 v[144:145], v[42:43], v[6:7] op_sel:[0,1] op_sel_hi:[1,1]
    v_pk_mul_f32 v[146:147], v[50:51], v[6:7] op_sel:[0,1] op_sel_hi:[1,1]
    v_exp_f32 v144, v144
    v_fract_f32 v146, v146
    v_exp_f32 v145, v145
    v_fract_f32 v147, v147
    v_cos_f32 v148, v146
    v_sin_f32 v146, v146
    v_cos_f32 v149, v147
    v_sin_f32 v147, v147
    v_pk_mul_f32 v[136:137], v[144:145], v[148:149]
    v_pk_mul_f32 v[138:139], v[144:145], v[146:147]
    v_pk_mul_f32 v[144:145], v[42:43], v[26:27] op_sel:[0,1] op_sel_hi:[1,1]
    v_pk_mul_f32 v[146:147], v[50:51], v[26:27] op_sel:[0,1] op_sel_hi:[1,1]
    v_exp_f32 v144, v144
    v_fract_f32 v146, v146
    v_exp_f32 v145, v145
    v_fract_f32 v147, v147
    v_cos_f32 v148, v146
    v_sin_f32 v146, v146
    v_cos_f32 v149, v147
    v_sin_f32 v147, v147
    v_pk_mul_f32 v[140:141], v[144:145], v[148:149]
    v_pk_mul_f32 v[142:143], v[144:145], v[146:147]
    v_pk_mul_f32 v[150:151], v[58:59], v[140:141]
    v_pk_mul_f32 v[152:153], v[58:59], v[142:143]
    v_pk_fma_f32 v[150:151], v[66:67], v[142:143], v[150:151] neg_lo:[1,0,0] neg_hi:[1,0,0]
    v_pk_fma_f32 v[152:153], v[66:67], v[140:141], v[152:153]
    v_cvt_pk_f16_f32 v81, v136, v137
    v_cvt_pk_f16_f32 v85, v138, v139
    v_cvt_pk_f16_f32 v73, v150, v151
    v_cvt_pk_f16_f32 v77, -v152, -v153
    v_pk_mul_f32 v[154:155], v[136:137], v[138:139]
    v_pk_mul_f32 v[156:157], v[138:139], v[138:139]
    v_pk_fma_f32 v[136:137], v[136:137], v[136:137], v[156:157] neg_lo:[0,0,1] neg_hi:[0,0,1]
    v_pk_add_f32 v[138:139], v[154:155], v[154:155]
    v_pk_mul_f32 v[154:155], v[140:141], v[142:143]
    v_pk_mul_f32 v[156:157], v[142:143], v[142:143]
    v_pk_fma_f32 v[140:141], v[140:141], v[140:141], v[156:157] neg_lo:[0,0,1] neg_hi:[0,0,1]
    v_pk_add_f32 v[142:143], v[154:155], v[154:155]
    v_pk_mul_f32 v[150:151], v[58:59], v[140:141]
    v_pk_mul_f32 v[152:153], v[58:59], v[142:143]
    v_pk_fma_f32 v[150:151], v[66:67], v[142:143], v[150:151] neg_lo:[1,0,0] neg_hi:[1,0,0]
    v_pk_fma_f32 v[152:153], v[66:67], v[140:141], v[152:153]
    v_cvt_pk_f16_f32 v97, v136, v137
    v_cvt_pk_f16_f32 v101, v138, v139
    v_cvt_pk_f16_f32 v89, v150, v151
    v_cvt_pk_f16_f32 v93, -v152, -v153
    v_pk_mul_f32 v[154:155], v[136:137], v[138:139]
    v_pk_mul_f32 v[156:157], v[138:139], v[138:139]
    v_pk_fma_f32 v[136:137], v[136:137], v[136:137], v[156:157] neg_lo:[0,0,1] neg_hi:[0,0,1]
    v_pk_add_f32 v[138:139], v[154:155], v[154:155]
    v_pk_mul_f32 v[154:155], v[140:141], v[142:143]
    v_pk_mul_f32 v[156:157], v[142:143], v[142:143]
    v_pk_fma_f32 v[140:141], v[140:141], v[140:141], v[156:157] neg_lo:[0,0,1] neg_hi:[0,0,1]
    v_pk_add_f32 v[142:143], v[154:155], v[154:155]
    v_pk_mul_f32 v[150:151], v[58:59], v[140:141]
    v_pk_mul_f32 v[152:153], v[58:59], v[142:143]
    v_pk_fma_f32 v[150:151], v[66:67], v[142:143], v[150:151] neg_lo:[1,0,0] neg_hi:[1,0,0]
    v_pk_fma_f32 v[152:153], v[66:67], v[140:141], v[152:153]
    v_cvt_pk_f16_f32 v113, v136, v137
    v_cvt_pk_f16_f32 v117, v138, v139
    v_cvt_pk_f16_f32 v105, v150, v151
    v_cvt_pk_f16_f32 v109, -v152, -v153
    v_pk_mul_f32 v[154:155], v[136:137], v[138:139]
    v_pk_mul_f32 v[156:157], v[138:139], v[138:139]
    v_pk_fma_f32 v[136:137], v[136:137], v[136:137], v[156:157] neg_lo:[0,0,1] neg_hi:[0,0,1]
    v_pk_add_f32 v[138:139], v[154:155], v[154:155]
    v_pk_mul_f32 v[154:155], v[140:141], v[142:143]
    v_pk_mul_f32 v[156:157], v[142:143], v[142:143]
    v_pk_fma_f32 v[140:141], v[140:141], v[140:141], v[156:157] neg_lo:[0,0,1] neg_hi:[0,0,1]
    v_pk_add_f32 v[142:143], v[154:155], v[154:155]
    v_pk_mul_f32 v[150:151], v[58:59], v[140:141]
    v_pk_mul_f32 v[152:153], v[58:59], v[142:143]
    v_pk_fma_f32 v[150:151], v[66:67], v[142:143], v[150:151] neg_lo:[1,0,0] neg_hi:[1,0,0]
    v_pk_fma_f32 v[152:153], v[66:67], v[140:141], v[152:153]
    v_cvt_pk_f16_f32 v129, v136, v137
    v_cvt_pk_f16_f32 v133, v138, v139
    v_cvt_pk_f16_f32 v121, v150, v151
    v_cvt_pk_f16_f32 v125, -v152, -v153
    v_pk_mul_f32 v[144:145], v[44:45], v[6:7] op_sel:[0,1] op_sel_hi:[1,1]
    v_pk_mul_f32 v[146:147], v[52:53], v[6:7] op_sel:[0,1] op_sel_hi:[1,1]
    v_exp_f32 v144, v144
    v_fract_f32 v146, v146
    v_exp_f32 v145, v145
    v_fract_f32 v147, v147
    v_cos_f32 v148, v146
    v_sin_f32 v146, v146
    v_cos_f32 v149, v147
    v_sin_f32 v147, v147
    v_pk_mul_f32 v[136:137], v[144:145], v[148:149]
    v_pk_mul_f32 v[138:139], v[144:145], v[146:147]
    v_pk_mul_f32 v[144:145], v[44:45], v[26:27] op_sel:[0,1] op_sel_hi:[1,1]
    v_pk_mul_f32 v[146:147], v[52:53], v[26:27] op_sel:[0,1] op_sel_hi:[1,1]
    v_exp_f32 v144, v144
    v_fract_f32 v146, v146
    v_exp_f32 v145, v145
    v_fract_f32 v147, v147
    v_cos_f32 v148, v146
    v_sin_f32 v146, v146
    v_cos_f32 v149, v147
    v_sin_f32 v147, v147
    v_pk_mul_f32 v[140:141], v[144:145], v[148:149]
    v_pk_mul_f32 v[142:143], v[144:145], v[146:147]
    v_pk_mul_f32 v[150:151], v[60:61], v[140:141]
    v_pk_mul_f32 v[152:153], v[60:61], v[142:143]
    v_pk_fma_f32 v[150:151], v[68:69], v[142:143], v[150:151] neg_lo:[1,0,0] neg_hi:[1,0,0]
    v_pk_fma_f32 v[152:153], v[68:69], v[140:141], v[152:153]
    v_cvt_pk_f16_f32 v82, v136, v137
    v_cvt_pk_f16_f32 v86, v138, v139
    v_cvt_pk_f16_f32 v74, v150, v151
    v_cvt_pk_f16_f32 v78, -v152, -v153
    v_pk_mul_f32 v[154:155], v[136:137], v[138:139]
    v_pk_mul_f32 v[156:157], v[138:139], v[138:139]
    v_pk_fma_f32 v[136:137], v[136:137], v[136:137], v[156:157] neg_lo:[0,0,1] neg_hi:[0,0,1]
    v_pk_add_f32 v[138:139], v[154:155], v[154:155]
    v_pk_mul_f32 v[154:155], v[140:141], v[142:143]
    v_pk_mul_f32 v[156:157], v[142:143], v[142:143]
    v_pk_fma_f32 v[140:141], v[140:141], v[140:141], v[156:157] neg_lo:[0,0,1] neg_hi:[0,0,1]
    v_pk_add_f32 v[142:143], v[154:155], v[154:155]
    v_pk_mul_f32 v[150:151], v[60:61], v[140:141]
    v_pk_mul_f32 v[152:153], v[60:61], v[142:143]
    v_pk_fma_f32 v[150:151], v[68:69], v[142:143], v[150:151] neg_lo:[1,0,0] neg_hi:[1,0,0]
    v_pk_fma_f32 v[152:153], v[68:69], v[140:141], v[152:153]
    v_cvt_pk_f16_f32 v98, v136, v137
    v_cvt_pk_f16_f32 v102, v138, v139
    v_cvt_pk_f16_f32 v90, v150, v151
    v_cvt_pk_f16_f32 v94, -v152, -v153
    v_pk_mul_f32 v[154:155], v[136:137], v[138:139]
    v_pk_mul_f32 v[156:157], v[138:139], v[138:139]
    v_pk_fma_f32 v[136:137], v[136:137], v[136:137], v[156:157] neg_lo:[0,0,1] neg_hi:[0,0,1]
    v_pk_add_f32 v[138:139], v[154:155], v[154:155]
    v_pk_mul_f32 v[154:155], v[140:141], v[142:143]
    v_pk_mul_f32 v[156:157], v[142:143], v[142:143]
    v_pk_fma_f32 v[140:141], v[140:141], v[140:141], v[156:157] neg_lo:[0,0,1] neg_hi:[0,0,1]
    v_pk_add_f32 v[142:143], v[154:155], v[154:155]
    v_pk_mul_f32 v[150:151], v[60:61], v[140:141]
    v_pk_mul_f32 v[152:153], v[60:61], v[142:143]
    v_pk_fma_f32 v[150:151], v[68:69], v[142:143], v[150:151] neg_lo:[1,0,0] neg_hi:[1,0,0]
    v_pk_fma_f32 v[152:153], v[68:69], v[140:141], v[152:153]
    v_cvt_pk_f16_f32 v114, v136, v137
    v_cvt_pk_f16_f32 v118, v138, v139
    v_cvt_pk_f16_f32 v106, v150, v151
    v_cvt_pk_f16_f32 v110, -v152, -v153
    v_pk_mul_f32 v[154:155], v[136:137], v[138:139]
    v_pk_mul_f32 v[156:157], v[138:139], v[138:139]
    v_pk_fma_f32 v[136:137], v[136:137], v[136:137], v[156:157] neg_lo:[0,0,1] neg_hi:[0,0,1]
    v_pk_add_f32 v[138:139], v[154:155], v[154:155]
    v_pk_mul_f32 v[154:155], v[140:141], v[142:143]
    v_pk_mul_f32 v[156:157], v[142:143], v[142:143]
    v_pk_fma_f32 v[140:141], v[140:141], v[140:141], v[156:157] neg_lo:[0,0,1] neg_hi:[0,0,1]
    v_pk_add_f32 v[142:143], v[154:155], v[154:155]
    v_pk_mul_f32 v[150:151], v[60:61], v[140:141]
    v_pk_mul_f32 v[152:153], v[60:61], v[142:143]
    v_pk_fma_f32 v[150:151], v[68:69], v[142:143], v[150:151] neg_lo:[1,0,0] neg_hi:[1,0,0]
    v_pk_fma_f32 v[152:153], v[68:69], v[140:141], v[152:153]
    v_cvt_pk_f16_f32 v130, v136, v137
    v_cvt_pk_f16_f32 v134, v138, v139
    v_cvt_pk_f16_f32 v122, v150, v151
    v_cvt_pk_f16_f32 v126, -v152, -v153
    v_pk_mul_f32 v[144:145], v[46:47], v[6:7] op_sel:[0,1] op_sel_hi:[1,1]
    v_pk_mul_f32 v[146:147], v[54:55], v[6:7] op_sel:[0,1] op_sel_hi:[1,1]
    v_exp_f32 v144, v144
    v_fract_f32 v146, v146
    v_exp_f32 v145, v145
    v_fract_f32 v147, v147
    v_cos_f32 v148, v146
    v_sin_f32 v146, v146
    v_cos_f32 v149, v147
    v_sin_f32 v147, v147
    v_pk_mul_f32 v[136:137], v[144:145], v[148:149]
    v_pk_mul_f32 v[138:139], v[144:145], v[146:147]
    v_pk_mul_f32 v[144:145], v[46:47], v[26:27] op_sel:[0,1] op_sel_hi:[1,1]
    v_pk_mul_f32 v[146:147], v[54:55], v[26:27] op_sel:[0,1] op_sel_hi:[1,1]
    v_exp_f32 v144, v144
    v_fract_f32 v146, v146
    v_exp_f32 v145, v145
    v_fract_f32 v147, v147
    v_cos_f32 v148, v146
    v_sin_f32 v146, v146
    v_cos_f32 v149, v147
    v_sin_f32 v147, v147
    v_pk_mul_f32 v[140:141], v[144:145], v[148:149]
    v_pk_mul_f32 v[142:143], v[144:145], v[146:147]
    v_pk_mul_f32 v[150:151], v[62:63], v[140:141]
    v_pk_mul_f32 v[152:153], v[62:63], v[142:143]
    v_pk_fma_f32 v[150:151], v[70:71], v[142:143], v[150:151] neg_lo:[1,0,0] neg_hi:[1,0,0]
    v_pk_fma_f32 v[152:153], v[70:71], v[140:141], v[152:153]
    v_cvt_pk_f16_f32 v83, v136, v137
    v_cvt_pk_f16_f32 v87, v138, v139
    v_cvt_pk_f16_f32 v75, v150, v151
    v_cvt_pk_f16_f32 v79, -v152, -v153
    v_pk_mul_f32 v[154:155], v[136:137], v[138:139]
    v_pk_mul_f32 v[156:157], v[138:139], v[138:139]
    v_pk_fma_f32 v[136:137], v[136:137], v[136:137], v[156:157] neg_lo:[0,0,1] neg_hi:[0,0,1]
    v_pk_add_f32 v[138:139], v[154:155], v[154:155]
    v_pk_mul_f32 v[154:155], v[140:141], v[142:143]
    v_pk_mul_f32 v[156:157], v[142:143], v[142:143]
    v_pk_fma_f32 v[140:141], v[140:141], v[140:141], v[156:157] neg_lo:[0,0,1] neg_hi:[0,0,1]
    v_pk_add_f32 v[142:143], v[154:155], v[154:155]
    v_pk_mul_f32 v[150:151], v[62:63], v[140:141]
    v_pk_mul_f32 v[152:153], v[62:63], v[142:143]
    v_pk_fma_f32 v[150:151], v[70:71], v[142:143], v[150:151] neg_lo:[1,0,0] neg_hi:[1,0,0]
    v_pk_fma_f32 v[152:153], v[70:71], v[140:141], v[152:153]
    v_cvt_pk_f16_f32 v99, v136, v137
    v_cvt_pk_f16_f32 v103, v138, v139
    v_cvt_pk_f16_f32 v91, v150, v151
    v_cvt_pk_f16_f32 v95, -v152, -v153
    v_pk_mul_f32 v[154:155], v[136:137], v[138:139]
    v_pk_mul_f32 v[156:157], v[138:139], v[138:139]
    v_pk_fma_f32 v[136:137], v[136:137], v[136:137], v[156:157] neg_lo:[0,0,1] neg_hi:[0,0,1]
    v_pk_add_f32 v[138:139], v[154:155], v[154:155]
    v_pk_mul_f32 v[154:155], v[140:141], v[142:143]
    v_pk_mul_f32 v[156:157], v[142:143], v[142:143]
    v_pk_fma_f32 v[140:141], v[140:141], v[140:141], v[156:157] neg_lo:[0,0,1] neg_hi:[0,0,1]
    v_pk_add_f32 v[142:143], v[154:155], v[154:155]
    v_pk_mul_f32 v[150:151], v[62:63], v[140:141]
    v_pk_mul_f32 v[152:153], v[62:63], v[142:143]
    v_pk_fma_f32 v[150:151], v[70:71], v[142:143], v[150:151] neg_lo:[1,0,0] neg_hi:[1,0,0]
    v_pk_fma_f32 v[152:153], v[70:71], v[140:141], v[152:153]
    v_cvt_pk_f16_f32 v115, v136, v137
    v_cvt_pk_f16_f32 v119, v138, v139
    v_cvt_pk_f16_f32 v107, v150, v151
    v_cvt_pk_f16_f32 v111, -v152, -v153
    v_pk_mul_f32 v[154:155], v[136:137], v[138:139]
    v_pk_mul_f32 v[156:157], v[138:139], v[138:139]
    v_pk_fma_f32 v[136:137], v[136:137], v[136:137], v[156:157] neg_lo:[0,0,1] neg_hi:[0,0,1]
    v_pk_add_f32 v[138:139], v[154:155], v[154:155]
    v_pk_mul_f32 v[154:155], v[140:141], v[142:143]
    v_pk_mul_f32 v[156:157], v[142:143], v[142:143]
    v_pk_fma_f32 v[140:141], v[140:141], v[140:141], v[156:157] neg_lo:[0,0,1] neg_hi:[0,0,1]
    v_pk_add_f32 v[142:143], v[154:155], v[154:155]
    v_pk_mul_f32 v[150:151], v[62:63], v[140:141]
    v_pk_mul_f32 v[152:153], v[62:63], v[142:143]
    v_pk_fma_f32 v[150:151], v[70:71], v[142:143], v[150:151] neg_lo:[1,0,0] neg_hi:[1,0,0]
    v_pk_fma_f32 v[152:153], v[70:71], v[140:141], v[152:153]
    v_cvt_pk_f16_f32 v131, v136, v137
    v_cvt_pk_f16_f32 v135, v138, v139
    v_cvt_pk_f16_f32 v123, v150, v151
    v_cvt_pk_f16_f32 v127, -v152, -v153
    v_mov_b32 v8, 0
    v_mov_b32 v9, 0
    v_mov_b32 v10, 0
    v_mov_b32 v11, 0
    v_mov_b32 v12, 0
    v_mov_b32 v13, 0
    v_mov_b32 v14, 0
    v_mov_b32 v15, 0
    v_mov_b32 v16, 0
    v_mov_b32 v17, 0
    v_mov_b32 v18, 0
    v_mov_b32 v19, 0
    v_mov_b32 v20, 0
    v_mov_b32 v21, 0
    v_mov_b32 v22, 0
    v_mov_b32 v23, 0
    v_mfma_f32_16x16x32_f16 v[8:11], v[72:75], v[80:83], v[8:11]
    v_mfma_f32_16x16x32_f16 v[8:11], v[76:79], v[84:87], v[8:11]
    v_mfma_f32_16x16x32_f16 v[12:15], v[88:91], v[96:99], v[12:15]
    v_mfma_f32_16x16x32_f16 v[12:15], v[92:95], v[100:103], v[12:15]
    v_mfma_f32_16x16x32_f16 v[16:19], v[104:107], v[112:115], v[16:19]
    v_mfma_f32_16x16x32_f16 v[16:19], v[108:111], v[116:119], v[16:19]
    v_mfma_f32_16x16x32_f16 v[20:23], v[120:123], v[128:131], v[20:23]
    v_mfma_f32_16x16x32_f16 v[20:23], v[124:127], v[132:135], v[20:23]
    v_lshlrev_b32 v40, 8, v2
    v_lshlrev_b32 v41, 2, v6
    v_add_u32 v40, v40, v41
    s_lshl_b32 s43, s3, 12
    v_add_u32 v40, s43, v40
    ds_write_b32 v40, v8 offset:0
    ds_write_b32 v40, v9 offset:64
    ds_write_b32 v40, v10 offset:128
    ds_write_b32 v40, v11 offset:192
    ds_write_b32 v40, v12 offset:1024
    ds_write_b32 v40, v13 offset:1088
    ds_write_b32 v40, v14 offset:1152
    ds_write_b32 v40, v15 offset:1216
    ds_write_b32 v40, v16 offset:2048
    ds_write_b32 v40, v17 offset:2112
    ds_write_b32 v40, v18 offset:2176
    ds_write_b32 v40, v19 offset:2240
    ds_write_b32 v40, v20 offset:3072
    ds_write_b32 v40, v21 offset:3136
    ds_write_b32 v40, v22 offset:3200
    ds_write_b32 v40, v23 offset:3264
    s_waitcnt lgkmcnt(0)
    s_barrier
    s_lshl_b32 s43, s3, 8
    v_lshlrev_b32 v41, 2, v0
    v_add_u32 v41, s43, v41
    v_add_f32 v42, v36, v36
    ds_read_b32 v44, v41 offset:0
    ds_read_b32 v45, v41 offset:4096
    ds_read_b32 v46, v41 offset:8192
    ds_read_b32 v47, v41 offset:12288
    ds_read_b32 v48, v41 offset:1024
    ds_read_b32 v49, v41 offset:5120
    ds_read_b32 v50, v41 offset:9216
    ds_read_b32 v51, v41 offset:13312
    ds_read_b32 v52, v41 offset:2048
    ds_read_b32 v53, v41 offset:6144
    ds_read_b32 v54, v41 offset:10240
    ds_read_b32 v55, v41 offset:14336
    ds_read_b32 v56, v41 offset:3072
    ds_read_b32 v57, v41 offset:7168
    ds_read_b32 v58, v41 offset:11264
    ds_read_b32 v59, v41 offset:15360
    s_waitcnt lgkmcnt(0)
    v_add_f32 v60, v44, v45
    v_add_f32 v64, v46, v47
    v_add_f32 v60, v60, v64
    v_mul_f32 v60, v60, v42
    v_add_f32 v61, v48, v49
    v_add_f32 v65, v50, v51
    v_add_f32 v61, v61, v65
    v_mul_f32 v61, v61, v42
    v_add_f32 v62, v52, v53
    v_add_f32 v66, v54, v55
    v_add_f32 v62, v62, v66
    v_mul_f32 v62, v62, v42
    v_add_f32 v63, v56, v57
    v_add_f32 v67, v58, v59
    v_add_f32 v63, v63, v67
    v_mul_f32 v63, v63, v42
    ds_write_b32 v41, v60 offset:16388
    v_mov_b32 v68, v60
    v_max_f32 v68, abs(v68), abs(v32)
    s_cmp_lt_u32 s3, 2
    s_cbranch_scc1 kc_lowhalf
    ds_write_b32 v41, v61 offset:16900
    v_max_f32 v68, v68, abs(v61)
    ds_write_b32 v41, v62 offset:17412
    v_max_f32 v68, v68, abs(v62)
    ds_write_b32 v41, v63 offset:17924
    v_max_f32 v68, v68, abs(v63)
    s_branch kc_join
kc_lowhalf:
    v_mov_b32 v69, 16384
    ds_write_b32 v69, v32
kc_join:
    v_max_f32_dpp v68, v68, v68 quad_perm:[1,0,3,2] row_mask:0xf bank_mask:0xf
    s_nop 1
    v_max_f32_dpp v68, v68, v68 quad_perm:[2,3,0,1] row_mask:0xf bank_mask:0xf
    s_nop 1
    v_max_f32_dpp v68, v68, v68 row_half_mirror row_mask:0xf bank_mask:0xf
    s_nop 1
    v_max_f32_dpp v68, v68, v68 row_mirror row_mask:0xf bank_mask:0xf
    s_nop 1
    v_max_f32_dpp v68, v68, v68 row_bcast:15 row_mask:0xa bank_mask:0xf
    s_nop 1
    v_max_f32_dpp v68, v68, v68 row_bcast:31 row_mask:0xc bank_mask:0xf
    s_nop 0
    v_readlane_b32 s54, v68, 63
    s_nop 1
    v_mov_b32 v69, s54
    s_lshl_b32 s43, s3, 2
    v_mov_b32 v70, s43
    ds_write_b32 v70, v69 offset:19456
    s_waitcnt lgkmcnt(0)
    s_barrier
    v_mov_b32 v70, 0
    ds_read_b128 v[72:75], v70 offset:19456
    s_waitcnt lgkmcnt(0)
    v_max_f32 v72, v72, v73
    v_max_f32 v74, v74, v75
    v_max_f32 v72, v72, v74
    v_lshrrev_b32 v73, 23, v72
    v_and_b32 v73, 0xff, v73
    v_max_u32 v73, 14, v73
    v_min_u32 v73, 0xfd, v73
    v_sub_u32 v74, 0x10b, v73
    v_lshlrev_b32 v74, 23, v74
    v_add_u32 v75, -13, v73
    v_lshlrev_b32 v75, 23, v75
    s_lshl_b32 s43, s3, 6
    v_add_u32 v76, s43, v0
    v_lshrrev_b32 v77, 2, v76
    v_lshlrev_b32 v77, 5, v77
    v_and_b32 v78, 3, v76
    v_lshlrev_b32 v78, 3, v78
    v_sub_u32 v77, v77, v78
    v_add_u32 v77, 31, v77
    v_add_u32 v80, 0, v77
    v_cvt_f32_u32 v88, v80
    v_lshrrev_b32 v96, 16, v88
    v_and_b32 v96, 1, v96
    v_add_u32 v88, v88, v96
    v_add_u32 v88, 0x7fff, v88
    v_lshrrev_b32 v88, 16, v88
    v_add_u32 v88, -17024, v88
    v_cmp_gt_u32 vcc, 128, v80
    s_nop 1
    v_cndmask_b32 v88, v88, v80, vcc
    v_lshlrev_b32 v88, 2, v88
    ds_read_b32 v96, v88 offset:16384
    v_add_u32 v81, -1, v77
    v_cvt_f32_u32 v89, v81
    v_lshrrev_b32 v97, 16, v89
    v_and_b32 v97, 1, v97
    v_add_u32 v89, v89, v97
    v_add_u32 v89, 0x7fff, v89
    v_lshrrev_b32 v89, 16, v89
    v_add_u32 v89, -17024, v89
    v_cmp_gt_u32 vcc, 128, v81
    s_nop 1
    v_cndmask_b32 v89, v89, v81, vcc
    v_lshlrev_b32 v89, 2, v89
    ds_read_b32 v97, v89 offset:16384
    v_add_u32 v82, -2, v77
    v_cvt_f32_u32 v90, v82
    v_lshrrev_b32 v98, 16, v90
    v_and_b32 v98, 1, v98
    v_add_u32 v90, v90, v98
    v_add_u32 v90, 0x7fff, v90
    v_lshrrev_b32 v90, 16, v90
    v_add_u32 v90, -17024, v90
    v_cmp_gt_u32 vcc, 128, v82
    s_nop 1
    v_cndmask_b32 v90, v90, v82, vcc
    v_lshlrev_b32 v90, 2, v90
    ds_read_b32 v98, v90 offset:16384
    v_add_u32 v83, -3, v77
    v_cvt_f32_u32 v91, v83
    v_lshrrev_b32 v99, 16, v91
    v_and_b32 v99, 1, v99
    v_add_u32 v91, v91, v99
    v_add_u32 v91, 0x7fff, v91
    v_lshrrev_b32 v91, 16, v91
    v_add_u32 v91, -17024, v91
    v_cmp_gt_u32 vcc, 128, v83
    s_nop 1
    v_cndmask_b32 v91, v91, v83, vcc
    v_lshlrev_b32 v91, 2, v91
    ds_read_b32 v99, v91 offset:16384
    v_add_u32 v84, -4, v77
    v_cvt_f32_u32 v92, v84
    v_lshrrev_b32 v100, 16, v92
    v_and_b32 v100, 1, v100
    v_add_u32 v92, v92, v100
    v_add_u32 v92, 0x7fff, v92
    v_lshrrev_b32 v92, 16, v92
    v_add_u32 v92, -17024, v92
    v_cmp_gt_u32 vcc, 128, v84
    s_nop 1
    v_cndmask_b32 v92, v92, v84, vcc
    v_lshlrev_b32 v92, 2, v92
    ds_read_b32 v100, v92 offset:16384
    v_add_u32 v85, -5, v77
    v_cvt_f32_u32 v93, v85
    v_lshrrev_b32 v101, 16, v93
    v_and_b32 v101, 1, v101
    v_add_u32 v93, v93, v101
    v_add_u32 v93, 0x7fff, v93
    v_lshrrev_b32 v93, 16, v93
    v_add_u32 v93, -17024, v93
    v_cmp_gt_u32 vcc, 128, v85
    s_nop 1
    v_cndmask_b32 v93, v93, v85, vcc
    v_lshlrev_b32 v93, 2, v93
    ds_read_b32 v101, v93 offset:16384
    v_add_u32 v86, -6, v77
    v_cvt_f32_u32 v94, v86
    v_lshrrev_b32 v102, 16, v94
    v_and_b32 v102, 1, v102
    v_add_u32 v94, v94, v102
    v_add_u32 v94, 0x7fff, v94
    v_lshrrev_b32 v94, 16, v94
    v_add_u32 v94, -17024, v94
    v_cmp_gt_u32 vcc, 128, v86
    s_nop 1
    v_cndmask_b32 v94, v94, v86, vcc
    v_lshlrev_b32 v94, 2, v94
    ds_read_b32 v102, v94 offset:16384
    v_add_u32 v87, -7, v77
    v_cvt_f32_u32 v95, v87
    v_lshrrev_b32 v103, 16, v95
    v_and_b32 v103, 1, v103
    v_add_u32 v95, v95, v103
    v_add_u32 v95, 0x7fff, v95
    v_lshrrev_b32 v95, 16, v95
    v_add_u32 v95, -17024, v95
    v_cmp_gt_u32 vcc, 128, v87
    s_nop 1
    v_cndmask_b32 v95, v95, v87, vcc
    v_lshlrev_b32 v95, 2, v95
    ds_read_b32 v103, v95 offset:16384
    s_waitcnt lgkmcnt(0)
    v_mul_f32 v96, v96, v74
    v_mul_f32 v97, v97, v74
    v_mul_f32 v98, v98, v74
    v_mul_f32 v99, v99, v74
    v_mul_f32 v100, v100, v74
    v_mul_f32 v101, v101, v74
    v_mul_f32 v102, v102, v74
    v_mul_f32 v103, v103, v74
    v_cvt_pk_f16_f32 v104, v96, v97
    v_cvt_pk_f16_f32 v105, v98, v99
    v_cvt_pk_f16_f32 v106, v100, v101
    v_cvt_pk_f16_f32 v107, v102, v103
    v_mov_b32 v127, v76
    v_mov_b32 v20, v75
    s_lshl_b32 s41, s40, 4
    s_lshl_b32 s42, s40, 12
    s_lshl_b32 s54, s40, 1
    v_lshlrev_b32 v2, 13, v127
    v_lshlrev_b32 v3, 4, v127
    v_mov_b32 v4, 0
    buffer_load_dwordx4 v[12:15], v2, s[44:47], s41 offen
    buffer_load_ushort v21, v4, s[72:75], s54 offen
    v_mov_b32 v24, 0
    v_mov_b32 v25, 0
    v_mov_b32 v26, 0
    v_mov_b32 v27, 0
    v_cmp_gt_u32 vcc, 155, v127
    s_and_saveexec_b64 s[56:57], vcc
    ds_write_b128 v3, v[24:27] offset:36864
    s_mov_b64 exec, s[56:57]
    v_lshrrev_b32 v5, 2, v127
    v_mul_u32_u24 v5, 80, v5
    v_and_b32 v6, 3, v127
    v_lshlrev_b32 v6, 4, v6
    v_add_u32 v5, v5, v6
    ds_write_b128 v5, v[104:107] offset:39344
    s_waitcnt lgkmcnt(0)
    s_barrier
    v_and_b32 v5, 7, v127
    v_mul_u32_u24 v5, 0x1040, v5
    v_lshrrev_b32 v6, 3, v127
    v_lshlrev_b32 v6, 4, v6
    v_add_u32 v5, v5, v6
    v_cmp_gt_u32 vcc, 24, v127
    s_and_saveexec_b64 s[56:57], vcc
    ds_write_b128 v5, v[24:27] offset:0
    s_mov_b64 exec, s[56:57]
    v_add_u32 v23, 48, v3
    s_waitcnt vmcnt(2)
    v_mov_b32 v8, v160
    v_mov_b32 v9, v161
    v_mov_b32 v10, v162
    v_mov_b32 v11, v163
    v_lshlrev_b32 v24, 16, v164
    v_and_b32 v25, 0xffff0000, v164
    v_cvt_pk_f16_f32 v32, v24, v25
    v_lshlrev_b32 v24, 16, v165
    v_and_b32 v25, 0xffff0000, v165
    v_cvt_pk_f16_f32 v33, v24, v25
    v_lshlrev_b32 v24, 16, v166
    v_and_b32 v25, 0xffff0000, v166
    v_cvt_pk_f16_f32 v34, v24, v25
    v_lshlrev_b32 v24, 16, v167
    v_and_b32 v25, 0xffff0000, v167
    v_cvt_pk_f16_f32 v35, v24, v25
    v_lshlrev_b32 v24, 16, v8
    v_and_b32 v25, 0xffff0000, v8
    v_cvt_pk_f16_f32 v36, v24, v25
    v_lshlrev_b32 v24, 16, v9
    v_and_b32 v25, 0xffff0000, v9
    v_cvt_pk_f16_f32 v37, v24, v25
    v_lshlrev_b32 v24, 16, v10
    v_and_b32 v25, 0xffff0000, v10
    v_cvt_pk_f16_f32 v38, v24, v25
    v_lshlrev_b32 v24, 16, v11
    v_and_b32 v25, 0xffff0000, v11
    v_cvt_pk_f16_f32 v39, v24, v25
    v_alignbyte_b32 v40, v33, v32, 2
    v_alignbyte_b32 v41, v34, v33, 2
    v_alignbyte_b32 v42, v35, v34, 2
    v_alignbyte_b32 v43, v36, v35, 2
    v_alignbyte_b32 v44, v37, v36, 2
    v_alignbyte_b32 v45, v38, v37, 2
    v_alignbyte_b32 v46, v39, v38, 2
    ds_write_b128 v23, v[32:35] offset:0
    ds_write_b128 v23, v[40:43] offset:4160
    v_mov_b32 v52, v33
    v_mov_b32 v53, v34
    v_mov_b32 v54, v35
    v_mov_b32 v55, v36
    ds_write_b128 v23, v[52:55] offset:8320
    v_mov_b32 v52, v41
    v_mov_b32 v53, v42
    v_mov_b32 v54, v43
    v_mov_b32 v55, v44
    ds_write_b128 v23, v[52:55] offset:12480
    ds_write_b128 v23, v[34:37] offset:16640
    ds_write_b128 v23, v[42:45] offset:20800
    v_mov_b32 v52, v35
    v_mov_b32 v53, v36
    v_mov_b32 v54, v37
    v_mov_b32 v55, v38
    ds_write_b128 v23, v[52:55] offset:24960
    v_mov_b32 v52, v43
    v_mov_b32 v53, v44
    v_mov_b32 v54, v45
    v_mov_b32 v55, v46
    ds_write_b128 v23, v[52:55] offset:29120
    v_cmp_eq_u32 vcc, 255, v127
    s_and_saveexec_b64 s[56:57], vcc
    s_cbranch_execz cv_nolast
    v_mov_b32 v32, v36
    v_mov_b32 v36, 0
    v_mov_b32 v33, v37
    v_mov_b32 v37, 0
    v_mov_b32 v34, v38
    v_mov_b32 v38, 0
    v_mov_b32 v35, v39
    v_mov_b32 v39, 0
    v_add_u32 v23, 16, v23
    v_alignbyte_b32 v40, v33, v32, 2
    v_alignbyte_b32 v41, v34, v33, 2
    v_alignbyte_b32 v42, v35, v34, 2
    v_alignbyte_b32 v43, v36, v35, 2
    v_alignbyte_b32 v44, v37, v36, 2
    v_alignbyte_b32 v45, v38, v37, 2
    v_alignbyte_b32 v46, v39, v38, 2
    ds_write_b128 v23, v[32:35] offset:0
    ds_write_b128 v23, v[40:43] offset:4160
    v_mov_b32 v52, v33
    v_mov_b32 v53, v34
    v_mov_b32 v54, v35
    v_mov_b32 v55, v36
    ds_write_b128 v23, v[52:55] offset:8320
    v_mov_b32 v52, v41
    v_mov_b32 v53, v42
    v_mov_b32 v54, v43
    v_mov_b32 v55, v44
    ds_write_b128 v23, v[52:55] offset:12480
    ds_write_b128 v23, v[34:37] offset:16640
    ds_write_b128 v23, v[42:45] offset:20800
    v_mov_b32 v52, v35
    v_mov_b32 v53, v36
    v_mov_b32 v54, v37
    v_mov_b32 v55, v38
    ds_write_b128 v23, v[52:55] offset:24960
    v_mov_b32 v52, v43
    v_mov_b32 v53, v44
    v_mov_b32 v54, v45
    v_mov_b32 v55, v46
    ds_write_b128 v23, v[52:55] offset:29120
cv_nolast:
    s_mov_b64 exec, s[56:57]
    s_waitcnt lgkmcnt(0)
    s_barrier
    v_and_b32 v5, 31, v0
    v_lshrrev_b32 v6, 5, v0
    v_add_u32 v7, 1, v5
    v_and_b32 v22, 7, v7
    v_mul_u32_u24 v22, 0x1040, v22
    v_lshrrev_b32 v7, 3, v7
    v_lshlrev_b32 v7, 4, v7
    v_add_u32 v7, v7, v22
    v_lshlrev_b32 v22, 4, v6
    v_add_u32 v7, v7, v22
    s_lshl_b32 s49, s3, 6
    v_add_u32 v7, s49, v7
    v_mul_u32_u24 v23, 80, v5
    v_add_u32 v23, v23, v22
    s_mul_i32 s49, s3, 80
    s_sub_u32 s49, 34544, s49
    v_add_u32 v23, s49, v23
    v_mov_b32 v32, 0
    v_mov_b32 v33, 0
    v_mov_b32 v34, 0
    v_mov_b32 v35, 0
    v_mov_b32 v36, 0
    v_mov_b32 v37, 0
    v_mov_b32 v38, 0
    v_mov_b32 v39, 0
    v_mov_b32 v40, 0
    v_mov_b32 v41, 0
    v_mov_b32 v42, 0
    v_mov_b32 v43, 0
    v_mov_b32 v44, 0
    v_mov_b32 v45, 0
    v_mov_b32 v46, 0
    v_mov_b32 v47, 0
    v_mov_b32 v48, 0
    v_mov_b32 v49, 0
    v_mov_b32 v50, 0
    v_mov_b32 v51, 0
    v_mov_b32 v52, 0
    v_mov_b32 v53, 0
    v_mov_b32 v54, 0
    v_mov_b32 v55, 0
    v_mov_b32 v56, 0
    v_mov_b32 v57, 0
    v_mov_b32 v58, 0
    v_mov_b32 v59, 0
    v_mov_b32 v60, 0
    v_mov_b32 v61, 0
    v_mov_b32 v62, 0
    v_mov_b32 v63, 0
    ds_read_b128 v[64:67], v7 offset:0
    ds_read_b128 v[72:75], v23 offset:4800
    ds_read_b128 v[80:83], v23 offset:7360
    ds_read_b128 v[68:71], v7 offset:32
    ds_read_b128 v[76:79], v23 offset:4832
    ds_read_b128 v[84:87], v23 offset:7392
    ds_read_b128 v[88:91], v7 offset:256
    ds_read_b128 v[96:99], v23 offset:4480
    ds_read_b128 v[104:107], v23 offset:7040
    ds_read_b128 v[92:95], v7 offset:288
    ds_read_b128 v[100:103], v23 offset:4512
    ds_read_b128 v[108:111], v23 offset:7072
    s_waitcnt lgkmcnt(6)
    v_mfma_f32_32x32x16_f16 v[32:47], v[64:67], v[72:75], v[32:47]
    v_mfma_f32_32x32x16_f16 v[48:63], v[64:67], v[80:83], v[48:63]
    v_mfma_f32_32x32x16_f16 v[32:47], v[68:71], v[76:79], v[32:47]
    v_mfma_f32_32x32x16_f16 v[48:63], v[68:71], v[84:87], v[48:63]
    ds_read_b128 v[64:67], v7 offset:512
    ds_read_b128 v[72:75], v23 offset:4160
    ds_read_b128 v[80:83], v23 offset:6720
    ds_read_b128 v[68:71], v7 offset:544
    ds_read_b128 v[76:79], v23 offset:4192
    ds_read_b128 v[84:87], v23 offset:6752
    s_waitcnt lgkmcnt(6)
    v_mfma_f32_32x32x16_f16 v[32:47], v[88:91], v[96:99], v[32:47]
    v_mfma_f32_32x32x16_f16 v[48:63], v[88:91], v[104:107], v[48:63]
    v_mfma_f32_32x32x16_f16 v[32:47], v[92:95], v[100:103], v[32:47]
    v_mfma_f32_32x32x16_f16 v[48:63], v[92:95], v[108:111], v[48:63]
    ds_read_b128 v[88:91], v7 offset:768
    ds_read_b128 v[96:99], v23 offset:3840
    ds_read_b128 v[104:107], v23 offset:6400
    ds_read_b128 v[92:95], v7 offset:800
    ds_read_b128 v[100:103], v23 offset:3872
    ds_read_b128 v[108:111], v23 offset:6432
    s_waitcnt lgkmcnt(6)
    v_mfma_f32_32x32x16_f16 v[32:47], v[64:67], v[72:75], v[32:47]
    v_mfma_f32_32x32x16_f16 v[48:63], v[64:67], v[80:83], v[48:63]
    v_mfma_f32_32x32x16_f16 v[32:47], v[68:71], v[76:79], v[32:47]
    v_mfma_f32_32x32x16_f16 v[48:63], v[68:71], v[84:87], v[48:63]
    ds_read_b128 v[64:67], v7 offset:1024
    ds_read_b128 v[72:75], v23 offset:3520
    ds_read_b128 v[80:83], v23 offset:6080
    ds_read_b128 v[68:71], v7 offset:1056
    ds_read_b128 v[76:79], v23 offset:3552
    ds_read_b128 v[84:87], v23 offset:6112
    s_waitcnt lgkmcnt(6)
    v_mfma_f32_32x32x16_f16 v[32:47], v[88:91], v[96:99], v[32:47]
    v_mfma_f32_32x32x16_f16 v[48:63], v[88:91], v[104:107], v[48:63]
    v_mfma_f32_32x32x16_f16 v[32:47], v[92:95], v[100:103], v[32:47]
    v_mfma_f32_32x32x16_f16 v[48:63], v[92:95], v[108:111], v[48:63]
    ds_read_b128 v[88:91], v7 offset:1280
    ds_read_b128 v[96:99], v23 offset:3200
    ds_read_b128 v[104:107], v23 offset:5760
    ds_read_b128 v[92:95], v7 offset:1312
    ds_read_b128 v[100:103], v23 offset:3232
    ds_read_b128 v[108:111], v23 offset:5792
    s_waitcnt lgkmcnt(6)
    v_mfma_f32_32x32x16_f16 v[32:47], v[64:67], v[72:75], v[32:47]
    v_mfma_f32_32x32x16_f16 v[48:63], v[64:67], v[80:83], v[48:63]
    v_mfma_f32_32x32x16_f16 v[32:47], v[68:71], v[76:79], v[32:47]
    v_mfma_f32_32x32x16_f16 v[48:63], v[68:71], v[84:87], v[48:63]
    ds_read_b128 v[64:67], v7 offset:1536
    ds_read_b128 v[72:75], v23 offset:2880
    ds_read_b128 v[80:83], v23 offset:5440
    ds_read_b128 v[68:71], v7 offset:1568
    ds_read_b128 v[76:79], v23 offset:2912
    ds_read_b128 v[84:87], v23 offset:5472
    s_waitcnt lgkmcnt(6)
    v_mfma_f32_32x32x16_f16 v[32:47], v[88:91], v[96:99], v[32:47]
    v_mfma_f32_32x32x16_f16 v[48:63], v[88:91], v[104:107], v[48:63]
    v_mfma_f32_32x32x16_f16 v[32:47], v[92:95], v[100:103], v[32:47]
    v_mfma_f32_32x32x16_f16 v[48:63], v[92:95], v[108:111], v[48:63]
    ds_read_b128 v[88:91], v7 offset:1792
    ds_read_b128 v[96:99], v23 offset:2560
    ds_read_b128 v[104:107], v23 offset:5120
    ds_read_b128 v[92:95], v7 offset:1824
    ds_read_b128 v[100:103], v23 offset:2592
    ds_read_b128 v[108:111], v23 offset:5152
    s_waitcnt lgkmcnt(6)
    v_mfma_f32_32x32x16_f16 v[32:47], v[64:67], v[72:75], v[32:47]
    v_mfma_f32_32x32x16_f16 v[48:63], v[64:67], v[80:83], v[48:63]
    v_mfma_f32_32x32x16_f16 v[32:47], v[68:71], v[76:79], v[32:47]
    v_mfma_f32_32x32x16_f16 v[48:63], v[68:71], v[84:87], v[48:63]
    ds_read_b128 v[64:67], v7 offset:2048
    ds_read_b128 v[80:83], v23 offset:4800
    ds_read_b128 v[68:71], v7 offset:2080
    ds_read_b128 v[84:87], v23 offset:4832
    s_waitcnt lgkmcnt(4)
    v_mfma_f32_32x32x16_f16 v[32:47], v[88:91], v[96:99], v[32:47]
    v_mfma_f32_32x32x16_f16 v[48:63], v[88:91], v[104:107], v[48:63]
    v_mfma_f32_32x32x16_f16 v[32:47], v[92:95], v[100:103], v[32:47]
    v_mfma_f32_32x32x16_f16 v[48:63], v[92:95], v[108:111], v[48:63]
    ds_read_b128 v[88:91], v7 offset:2304
    ds_read_b128 v[104:107], v23 offset:4480
    ds_read_b128 v[92:95], v7 offset:2336
    ds_read_b128 v[108:111], v23 offset:4512
    s_waitcnt lgkmcnt(4)
    v_mfma_f32_32x32x16_f16 v[48:63], v[64:67], v[80:83], v[48:63]
    v_mfma_f32_32x32x16_f16 v[48:63], v[68:71], v[84:87], v[48:63]
    ds_read_b128 v[64:67], v7 offset:2560
    ds_read_b128 v[80:83], v23 offset:4160
    ds_read_b128 v[68:71], v7 offset:2592
    ds_read_b128 v[84:87], v23 offset:4192
    s_waitcnt lgkmcnt(4)
    v_mfma_f32_32x32x16_f16 v[48:63], v[88:91], v[104:107], v[48:63]
    v_mfma_f32_32x32x16_f16 v[48:63], v[92:95], v[108:111], v[48:63]
    ds_read_b128 v[88:91], v7 offset:2816
    ds_read_b128 v[104:107], v23 offset:3840
    ds_read_b128 v[92:95], v7 offset:2848
    ds_read_b128 v[108:111], v23 offset:3872
    s_waitcnt lgkmcnt(4)
    v_mfma_f32_32x32x16_f16 v[48:63], v[64:67], v[80:83], v[48:63]
    v_mfma_f32_32x32x16_f16 v[48:63], v[68:71], v[84:87], v[48:63]
    ds_read_b128 v[64:67], v7 offset:3072
    ds_read_b128 v[80:83], v23 offset:3520
    ds_read_b128 v[68:71], v7 offset:3104
    ds_read_b128 v[84:87], v23 offset:3552
    s_waitcnt lgkmcnt(4)
    v_mfma_f32_32x32x16_f16 v[48:63], v[88:91], v[104:107], v[48:63]
    v_mfma_f32_32x32x16_f16 v[48:63], v[92:95], v[108:111], v[48:63]
    ds_read_b128 v[88:91], v7 offset:3328
    ds_read_b128 v[104:107], v23 offset:3200
    ds_read_b128 v[92:95], v7 offset:3360
    ds_read_b128 v[108:111], v23 offset:3232
    s_waitcnt lgkmcnt(4)
    v_mfma_f32_32x32x16_f16 v[48:63], v[64:67], v[80:83], v[48:63]
    v_mfma_f32_32x32x16_f16 v[48:63], v[68:71], v[84:87], v[48:63]
    ds_read_b128 v[64:67], v7 offset:3584
    ds_read_b128 v[80:83], v23 offset:2880
    ds_read_b128 v[68:71], v7 offset:3616
    ds_read_b128 v[84:87], v23 offset:2912
    s_waitcnt lgkmcnt(4)
    v_mfma_f32_32x32x16_f16 v[48:63], v[88:91], v[104:107], v[48:63]
    v_mfma_f32_32x32x16_f16 v[48:63], v[92:95], v[108:111], v[48:63]
    ds_read_b128 v[88:91], v7 offset:3840
    ds_read_b128 v[104:107], v23 offset:2560
    ds_read_b128 v[92:95], v7 offset:3872
    ds_read_b128 v[108:111], v23 offset:2592
    s_waitcnt lgkmcnt(4)
    v_mfma_f32_32x32x16_f16 v[48:63], v[64:67], v[80:83], v[48:63]
    v_mfma_f32_32x32x16_f16 v[48:63], v[68:71], v[84:87], v[48:63]
    s_waitcnt lgkmcnt(0)
    v_mfma_f32_32x32x16_f16 v[48:63], v[88:91], v[104:107], v[48:63]
    v_mfma_f32_32x32x16_f16 v[48:63], v[92:95], v[108:111], v[48:63]
    s_barrier
    v_mul_u32_u24 v5, 144, v5
    v_add_u32 v5, v5, v22
    s_mul_i32 s49, s3, 9216
    v_add_u32 v5, s49, v5
    ds_write_b128 v5, v[32:35] offset:0
    ds_write_b128 v5, v[36:39] offset:32
    ds_write_b128 v5, v[40:43] offset:64
    ds_write_b128 v5, v[44:47] offset:96
    s_nop 2
    ds_write_b128 v5, v[48:51] offset:4608
    ds_write_b128 v5, v[52:55] offset:4640
    ds_write_b128 v5, v[56:59] offset:4672
    ds_write_b128 v5, v[60:63] offset:4704
    s_waitcnt lgkmcnt(0)
    s_barrier
    v_lshrrev_b32 v5, 2, v127
    v_mul_u32_u24 v5, 144, v5
    v_and_b32 v6, 3, v127
    v_lshlrev_b32 v6, 5, v6
    v_add_u32 v5, v5, v6
    ds_read_b128 v[64:67], v5 offset:0
    ds_read_b128 v[68:71], v5 offset:16
    ds_read_b128 v[72:75], v5 offset:9216
    ds_read_b128 v[76:79], v5 offset:9232
    ds_read_b128 v[80:83], v5 offset:18432
    ds_read_b128 v[84:87], v5 offset:18448
    ds_read_b128 v[88:91], v5 offset:27648
    ds_read_b128 v[92:95], v5 offset:27664
    s_waitcnt vmcnt(0) lgkmcnt(0)
    v_lshlrev_b32 v21, 16, v21
    v_add_f32 v64, v64, v72
    v_add_f32 v80, v80, v88
    v_add_f32 v64, v64, v80
    v_mul_f32 v64, v64, v20
    v_add_f32 v65, v65, v73
    v_add_f32 v81, v81, v89
    v_add_f32 v65, v65, v81
    v_mul_f32 v65, v65, v20
    v_add_f32 v66, v66, v74
    v_add_f32 v82, v82, v90
    v_add_f32 v66, v66, v82
    v_mul_f32 v66, v66, v20
    v_add_f32 v67, v67, v75
    v_add_f32 v83, v83, v91
    v_add_f32 v67, v67, v83
    v_mul_f32 v67, v67, v20
    v_add_f32 v68, v68, v76
    v_add_f32 v84, v84, v92
    v_add_f32 v68, v68, v84
    v_mul_f32 v68, v68, v20
    v_add_f32 v69, v69, v77
    v_add_f32 v85, v85, v93
    v_add_f32 v69, v69, v85
    v_mul_f32 v69, v69, v20
    v_add_f32 v70, v70, v78
    v_add_f32 v86, v86, v94
    v_add_f32 v70, v70, v86
    v_mul_f32 v70, v70, v20
    v_add_f32 v71, v71, v79
    v_add_f32 v87, v87, v95
    v_add_f32 v71, v71, v87
    v_mul_f32 v71, v71, v20
    v_cvt_pk_bf16_f32 v72, v64, v65
    v_lshlrev_b32 v73, 16, v72
    v_and_b32 v74, 0xffff0000, v72
    v_lshlrev_b32 v75, 16, v8
    v_and_b32 v76, 0xffff0000, v8
    v_mul_f32 v75, v75, v21
    v_mul_f32 v76, v76, v21
    v_cvt_pk_bf16_f32 v72, v75, v76
    v_lshlrev_b32 v75, 16, v72
    v_and_b32 v76, 0xffff0000, v72
    v_add_f32 v73, v73, v75
    v_add_f32 v74, v74, v76
    v_cvt_pk_bf16_f32 v72, v73, v74
    v_lshlrev_b32 v73, 16, v72
    v_and_b32 v74, 0xffff0000, v72
    v_lshlrev_b32 v75, 16, v12
    v_and_b32 v76, 0xffff0000, v12
    v_add_f32 v73, v75, v73
    v_add_f32 v74, v76, v74
    v_cvt_pk_bf16_f32 v80, v73, v74
    v_cvt_pk_bf16_f32 v72, v66, v67
    v_lshlrev_b32 v73, 16, v72
    v_and_b32 v74, 0xffff0000, v72
    v_lshlrev_b32 v75, 16, v9
    v_and_b32 v76, 0xffff0000, v9
    v_mul_f32 v75, v75, v21
    v_mul_f32 v76, v76, v21
    v_cvt_pk_bf16_f32 v72, v75, v76
    v_lshlrev_b32 v75, 16, v72
    v_and_b32 v76, 0xffff0000, v72
    v_add_f32 v73, v73, v75
    v_add_f32 v74, v74, v76
    v_cvt_pk_bf16_f32 v72, v73, v74
    v_lshlrev_b32 v73, 16, v72
    v_and_b32 v74, 0xffff0000, v72
    v_lshlrev_b32 v75, 16, v13
    v_and_b32 v76, 0xffff0000, v13
    v_add_f32 v73, v75, v73
    v_add_f32 v74, v76, v74
    v_cvt_pk_bf16_f32 v81, v73, v74
    v_cvt_pk_bf16_f32 v72, v68, v69
    v_lshlrev_b32 v73, 16, v72
    v_and_b32 v74, 0xffff0000, v72
    v_lshlrev_b32 v75, 16, v10
    v_and_b32 v76, 0xffff0000, v10
    v_mul_f32 v75, v75, v21
    v_mul_f32 v76, v76, v21
    v_cvt_pk_bf16_f32 v72, v75, v76
    v_lshlrev_b32 v75, 16, v72
    v_and_b32 v76, 0xffff0000, v72
    v_add_f32 v73, v73, v75
    v_add_f32 v74, v74, v76
    v_cvt_pk_bf16_f32 v72, v73, v74
    v_lshlrev_b32 v73, 16, v72
    v_and_b32 v74, 0xffff0000, v72
    v_lshlrev_b32 v75, 16, v14
    v_and_b32 v76, 0xffff0000, v14
    v_add_f32 v73, v75, v73
    v_add_f32 v74, v76, v74
    v_cvt_pk_bf16_f32 v82, v73, v74
    v_cvt_pk_bf16_f32 v72, v70, v71
    v_lshlrev_b32 v73, 16, v72
    v_and_b32 v74, 0xffff0000, v72
    v_lshlrev_b32 v75, 16, v11
    v_and_b32 v76, 0xffff0000, v11
    v_mul_f32 v75, v75, v21
    v_mul_f32 v76, v76, v21
    v_cvt_pk_bf16_f32 v72, v75, v76
    v_lshlrev_b32 v75, 16, v72
    v_and_b32 v76, 0xffff0000, v72
    v_add_f32 v73, v73, v75
    v_add_f32 v74, v74, v76
    v_cvt_pk_bf16_f32 v72, v73, v74
    v_lshlrev_b32 v73, 16, v72
    v_and_b32 v74, 0xffff0000, v72
    v_lshlrev_b32 v75, 16, v15
    v_and_b32 v76, 0xffff0000, v15
    v_add_f32 v73, v75, v73
    v_add_f32 v74, v76, v74
    v_cvt_pk_bf16_f32 v83, v73, v74
    buffer_store_dwordx4 v[80:83], v3, s[76:79], s42 offen
    s_endpgm
k1_pf:
    s_sub_u32 s2, s2, 736
    s_load_dwordx2 s[18:19], s[0:1], 80
    s_waitcnt lgkmcnt(0)
    s_mov_b32 s20, s18
    s_and_b32 s21, s19, 0xffff
    s_mov_b32 s22, 0x700000
    s_mov_b32 s23, 0x00020000
    s_and_b32 s40, s2, 7
    s_lshr_b32 s41, s2, 3
    s_lshr_b32 s42, s41, 0
    s_lshl_b32 s43, s42, 3
    s_add_u32 s43, s43, s40
    s_and_b32 s41, s41, 0
    s_lshl_b32 s41, s41, 2
    s_add_u32 s41, s41, s3
    s_mul_i32 s41, s41, 1835008
    s_lshl_b32 s43, s43, 7
    s_add_u32 s41, s41, s43
    v_lshrrev_b32 v2, 3, v0
    s_mov_b32 s42, 4096
    v_mul_u32_u24 v2, s42, v2
    v_and_b32 v3, 7, v0
    v_lshlrev_b32 v3, 4, v3
    v_add_u32 v2, v2, v3
    buffer_load_dwordx4 v[8:11], v2, s[20:23], s41 offen
    s_add_u32 s41, s41, 32768
    buffer_load_dwordx4 v[12:15], v2, s[20:23], s41 offen
    s_add_u32 s41, s41, 32768
    buffer_load_dwordx4 v[16:19], v2, s[20:23], s41 offen
    s_add_u32 s41, s41, 32768
    buffer_load_dwordx4 v[20:23], v2, s[20:23], s41 offen
    s_add_u32 s41, s41, 32768
    buffer_load_dwordx4 v[24:27], v2, s[20:23], s41 offen
    s_add_u32 s41, s41, 32768
    buffer_load_dwordx4 v[28:31], v2, s[20:23], s41 offen
    s_add_u32 s41, s41, 32768
    buffer_load_dwordx4 v[32:35], v2, s[20:23], s41 offen
    s_add_u32 s41, s41, 32768
    buffer_load_dwordx4 v[36:39], v2, s[20:23], s41 offen
    s_add_u32 s41, s41, 32768
    s_waitcnt vmcnt(7)
    buffer_load_dwordx4 v[40:43], v2, s[20:23], s41 offen
    s_add_u32 s41, s41, 32768
    s_waitcnt vmcnt(7)
    buffer_load_dwordx4 v[44:47], v2, s[20:23], s41 offen
    s_add_u32 s41, s41, 32768
    s_waitcnt vmcnt(7)
    buffer_load_dwordx4 v[48:51], v2, s[20:23], s41 offen
    s_add_u32 s41, s41, 32768
    s_waitcnt vmcnt(7)
    buffer_load_dwordx4 v[52:55], v2, s[20:23], s41 offen
    s_add_u32 s41, s41, 32768
    s_waitcnt vmcnt(7)
    buffer_load_dwordx4 v[56:59], v2, s[20:23], s41 offen
    s_add_u32 s41, s41, 32768
    s_waitcnt vmcnt(7)
    buffer_load_dwordx4 v[60:63], v2, s[20:23], s41 offen
    s_add_u32 s41, s41, 32768
    s_waitcnt vmcnt(7)
    buffer_load_dwordx4 v[64:67], v2, s[20:23], s41 offen
    s_add_u32 s41, s41, 32768
    s_waitcnt vmcnt(7)
    buffer_load_dwordx4 v[68:71], v2, s[20:23], s41 offen
    s_add_u32 s41, s41, 32768
    s_waitcnt vmcnt(7)
    buffer_load_dwordx4 v[8:11], v2, s[20:23], s41 offen
    s_add_u32 s41, s41, 32768
    s_waitcnt vmcnt(7)
    buffer_load_dwordx4 v[12:15], v2, s[20:23], s41 offen
    s_add_u32 s41, s41, 32768
    s_waitcnt vmcnt(7)
    buffer_load_dwordx4 v[16:19], v2, s[20:23], s41 offen
    s_add_u32 s41, s41, 32768
    s_waitcnt vmcnt(7)
    buffer_load_dwordx4 v[20:23], v2, s[20:23], s41 offen
    s_add_u32 s41, s41, 32768
    s_waitcnt vmcnt(7)
    buffer_load_dwordx4 v[24:27], v2, s[20:23], s41 offen
    s_add_u32 s41, s41, 32768
    s_waitcnt vmcnt(7)
    buffer_load_dwordx4 v[28:31], v2, s[20:23], s41 offen
    s_add_u32 s41, s41, 32768
    s_waitcnt vmcnt(7)
    buffer_load_dwordx4 v[32:35], v2, s[20:23], s41 offen
    s_add_u32 s41, s41, 32768
    s_waitcnt vmcnt(7)
    buffer_load_dwordx4 v[36:39], v2, s[20:23], s41 offen
    s_add_u32 s41, s41, 32768
    s_waitcnt vmcnt(7)
    buffer_load_dwordx4 v[40:43], v2, s[20:23], s41 offen
    s_add_u32 s41, s41, 32768
    s_waitcnt vmcnt(7)
    buffer_load_dwordx4 v[44:47], v2, s[20:23], s41 offen
    s_add_u32 s41, s41, 32768
    s_waitcnt vmcnt(7)
    buffer_load_dwordx4 v[48:51], v2, s[20:23], s41 offen
    s_add_u32 s41, s41, 32768
    s_waitcnt vmcnt(7)
    buffer_load_dwordx4 v[52:55], v2, s[20:23], s41 offen
    s_add_u32 s41, s41, 32768
    s_waitcnt vmcnt(7)
    buffer_load_dwordx4 v[56:59], v2, s[20:23], s41 offen
    s_add_u32 s41, s41, 32768
    s_waitcnt vmcnt(7)
    buffer_load_dwordx4 v[60:63], v2, s[20:23], s41 offen
    s_add_u32 s41, s41, 32768
    s_waitcnt vmcnt(7)
    buffer_load_dwordx4 v[64:67], v2, s[20:23], s41 offen
    s_add_u32 s41, s41, 32768
    s_waitcnt vmcnt(7)
    buffer_load_dwordx4 v[68:71], v2, s[20:23], s41 offen
    s_add_u32 s41, s41, 32768
    s_waitcnt vmcnt(7)
    buffer_load_dwordx4 v[8:11], v2, s[20:23], s41 offen
    s_add_u32 s41, s41, 32768
    s_waitcnt vmcnt(7)
    buffer_load_dwordx4 v[12:15], v2, s[20:23], s41 offen
    s_add_u32 s41, s41, 32768
    s_waitcnt vmcnt(7)
    buffer_load_dwordx4 v[16:19], v2, s[20:23], s41 offen
    s_add_u32 s41, s41, 32768
    s_waitcnt vmcnt(7)
    buffer_load_dwordx4 v[20:23], v2, s[20:23], s41 offen
    s_add_u32 s41, s41, 32768
    s_waitcnt vmcnt(7)
    buffer_load_dwordx4 v[24:27], v2, s[20:23], s41 offen
    s_add_u32 s41, s41, 32768
    s_waitcnt vmcnt(7)
    buffer_load_dwordx4 v[28:31], v2, s[20:23], s41 offen
    s_add_u32 s41, s41, 32768
    s_waitcnt vmcnt(7)
    buffer_load_dwordx4 v[32:35], v2, s[20:23], s41 offen
    s_add_u32 s41, s41, 32768
    s_waitcnt vmcnt(7)
    buffer_load_dwordx4 v[36:39], v2, s[20:23], s41 offen
    s_add_u32 s41, s41, 32768
    s_waitcnt vmcnt(7)
    buffer_load_dwordx4 v[40:43], v2, s[20:23], s41 offen
    s_add_u32 s41, s41, 32768
    s_waitcnt vmcnt(7)
    buffer_load_dwordx4 v[44:47], v2, s[20:23], s41 offen
    s_add_u32 s41, s41, 32768
    s_waitcnt vmcnt(7)
    buffer_load_dwordx4 v[48:51], v2, s[20:23], s41 offen
    s_add_u32 s41, s41, 32768
    s_waitcnt vmcnt(7)
    buffer_load_dwordx4 v[52:55], v2, s[20:23], s41 offen
    s_add_u32 s41, s41, 32768
    s_waitcnt vmcnt(7)
    buffer_load_dwordx4 v[56:59], v2, s[20:23], s41 offen
    s_add_u32 s41, s41, 32768
    s_waitcnt vmcnt(7)
    buffer_load_dwordx4 v[60:63], v2, s[20:23], s41 offen
    s_add_u32 s41, s41, 32768
    s_waitcnt vmcnt(7)
    buffer_load_dwordx4 v[64:67], v2, s[20:23], s41 offen
    s_add_u32 s41, s41, 32768
    s_waitcnt vmcnt(7)
    buffer_load_dwordx4 v[68:71], v2, s[20:23], s41 offen
    s_add_u32 s41, s41, 32768
    s_waitcnt vmcnt(7)
    buffer_load_dwordx4 v[8:11], v2, s[20:23], s41 offen
    s_add_u32 s41, s41, 32768
    s_waitcnt vmcnt(7)
    buffer_load_dwordx4 v[12:15], v2, s[20:23], s41 offen
    s_add_u32 s41, s41, 32768
    s_waitcnt vmcnt(7)
    buffer_load_dwordx4 v[16:19], v2, s[20:23], s41 offen
    s_add_u32 s41, s41, 32768
    s_waitcnt vmcnt(7)
    buffer_load_dwordx4 v[20:23], v2, s[20:23], s41 offen
    s_add_u32 s41, s41, 32768
    s_waitcnt vmcnt(7)
    buffer_load_dwordx4 v[24:27], v2, s[20:23], s41 offen
    s_add_u32 s41, s41, 32768
    s_waitcnt vmcnt(7)
    buffer_load_dwordx4 v[28:31], v2, s[20:23], s41 offen
    s_add_u32 s41, s41, 32768
    s_waitcnt vmcnt(7)
    buffer_load_dwordx4 v[32:35], v2, s[20:23], s41 offen
    s_add_u32 s41, s41, 32768
    s_waitcnt vmcnt(7)
    buffer_load_dwordx4 v[36:39], v2, s[20:23], s41 offen
    s_add_u32 s41, s41, 32768
    s_waitcnt vmcnt(7)
    s_waitcnt vmcnt(0)
    s_endpgm
k1_end:
    s_endpgm
.globl k2_kernel
.p2align 8
.type k2_kernel,@function
k2_kernel:
    s_load_dwordx2 s[4:5], s[0:1], 80
    s_load_dwordx2 s[6:7], s[0:1], 88
    s_load_dwordx2 s[8:9], s[0:1], 112
    s_load_dwordx2 s[10:11], s[0:1], 96
    v_lshrrev_b32 v1, 6, v0
    v_and_b32 v0, 63, v0
    v_readfirstlane_b32 s3, v1
    s_cmp_ge_u32 s2, 256
    s_cbranch_scc1 k2_end
    s_and_b32 s12, s2, 7
    s_lshr_b32 s13, s2, 3
    s_lshr_b32 s14, s13, 3
    s_lshl_b32 s14, s14, 3
    s_add_u32 s14, s14, s12
    s_and_b32 s15, s13, 7
    s_waitcnt lgkmcnt(0)
    s_mov_b32 s20, s4
    s_and_b32 s21, s5, 0xffff
    s_mov_b32 s22, 0x700000
    s_mov_b32 s23, 0x00020000
    s_add_u32 s24, s8, 0x600000
    s_addc_u32 s25, s9, 0
    s_and_b32 s25, s25, 0xffff
    s_mov_b32 s26, 0x1c0000
    s_mov_b32 s27, 0x00020000
    s_mov_b32 s28, s6
    s_and_b32 s29, s7, 0xffff
    s_mov_b32 s30, 0x1000
    s_mov_b32 s31, 0x00020000
    s_add_u32 s32, s8, 0xb00000
    s_addc_u32 s33, s9, 0
    s_and_b32 s33, s33, 0xffff
    s_mov_b32 s34, 0x200000
    s_mov_b32 s35, 0x00020000
    s_mov_b32 s36, s10
    s_and_b32 s37, s11, 0xffff
    s_mov_b32 s38, 0x200000
    s_mov_b32 s39, 0x00020000
    s_and_b32 s60, s3, 1
    s_lshr_b32 s61, s3, 1
    v_lshrrev_b32 v2, 3, v0
    s_mov_b32 s62, 4096
    v_mul_u32_u24 v2, s62, v2
    v_lshrrev_b32 v3, 4, v0
    v_and_b32 v3, 1, v3
    v_lshlrev_b32 v3, 2, v3
    v_and_b32 v4, 7, v0
    v_xor_b32 v3, v3, v4
    v_lshlrev_b32 v3, 4, v3
    v_add_u32 v2, v2, v3
    v_lshlrev_b32 v3, 4, v0
    s_mul_i32 s62, s3, 65536
    s_lshl_b32 s63, s14, 7
    s_add_u32 s62, s62, s63
    s_add_u32 s63, s62, 32768
    s_lshl_b32 s64, s3, 14
    s_lshl_b32 s65, s15, 10
    s_add_u32 s64, s64, s65
    s_add_u32 s65, s64, 8192
    s_lshl_b32 s66, s3, 11
    v_and_b32 v4, 15, v0
    v_lshrrev_b32 v5, 2, v4
    v_and_b32 v6, 3, v0
    v_lshrrev_b32 v7, 5, v0
    v_lshrrev_b32 v8, 4, v0
    v_and_b32 v8, 1, v8
    v_lshlrev_b32 v9, 3, v7
    v_add_u32 v9, v9, v5
    v_lshlrev_b32 v9, 3, v9
    v_lshlrev_b32 v10, 1, v8
    v_lshrrev_b32 v11, 1, v6
    v_add_u32 v10, v10, v11
    s_lshl_b32 s67, s60, 2
    v_add_u32 v10, s67, v10
    v_lshrrev_b32 v11, 1, v5
    v_and_b32 v11, 1, v11
    v_lshlrev_b32 v11, 2, v11
    v_xor_b32 v10, v10, v11
    v_add_u32 v9, v9, v10
    v_lshlrev_b32 v9, 4, v9
    v_and_b32 v10, 1, v6
    v_lshlrev_b32 v10, 3, v10
    v_add_u32 v4, v9, v10
    v_lshlrev_b32 v5, 6, v7
    v_and_b32 v6, 31, v0
    v_add_u32 v5, v5, v6
    s_lshl_b32 s67, s61, 5
    v_add_u32 v5, s67, v5
    v_lshlrev_b32 v5, 4, v5
    v_add_u32 v5, 0x2000, v5
    v_lshrrev_b32 v6, 5, v0
    v_lshlrev_b32 v6, 3, v6
    s_lshl_b32 s67, s60, 6
    v_add_u32 v6, s67, v6
    s_lshl_b32 s67, s14, 7
    buffer_load_dwordx2 v[64:65], v6, s[28:31], s67 offen offset:0
    buffer_load_dwordx2 v[66:67], v6, s[28:31], s67 offen offset:16
    buffer_load_dwordx2 v[68:69], v6, s[28:31], s67 offen offset:32
    buffer_load_dwordx2 v[70:71], v6, s[28:31], s67 offen offset:48
    v_and_b32 v7, 31, v0
    s_lshl_b32 s70, s61, 5
    v_add_u32 v7, s70, v7
    s_lshl_b32 s70, s15, 6
    v_add_u32 v7, s70, v7
    v_lshlrev_b32 v8, 12, v7
    v_add_u32 v8, v8, v6
    buffer_load_dwordx2 v[72:73], v8, s[32:35], s67 offen offset:0
    buffer_load_dwordx2 v[74:75], v8, s[32:35], s67 offen offset:16
    buffer_load_dwordx2 v[76:77], v8, s[32:35], s67 offen offset:32
    buffer_load_dwordx2 v[78:79], v8, s[32:35], s67 offen offset:48
    v_mov_b32 v16, 0
    v_mov_b32 v17, 0
    v_mov_b32 v18, 0
    v_mov_b32 v19, 0
    v_mov_b32 v20, 0
    v_mov_b32 v21, 0
    v_mov_b32 v22, 0
    v_mov_b32 v23, 0
    v_mov_b32 v24, 0
    v_mov_b32 v25, 0
    v_mov_b32 v26, 0
    v_mov_b32 v27, 0
    v_mov_b32 v28, 0
    v_mov_b32 v29, 0
    v_mov_b32 v30, 0
    v_mov_b32 v31, 0
    s_add_u32 m0, s66, 0
    s_nop 0
    buffer_load_dwordx4 v2, s[20:23], s62 offen lds
    s_add_u32 m0, s66, 1024
    s_nop 0
    buffer_load_dwordx4 v2, s[20:23], s63 offen lds
    s_add_u32 m0, s66, 8192
    s_nop 0
    buffer_load_dwordx4 v3, s[24:27], s64 offen lds
    s_add_u32 m0, s66, 9216
    s_nop 0
    buffer_load_dwordx4 v3, s[24:27], s65 offen lds
    s_add_u32 s62, s62, 262144
    s_add_u32 s63, s63, 262144
    s_add_u32 s64, s64, 0x10000
    s_add_u32 s65, s65, 0x10000
    s_add_u32 m0, s66, 16384
    s_nop 0
    buffer_load_dwordx4 v2, s[20:23], s62 offen lds
    s_add_u32 m0, s66, 17408
    s_nop 0
    buffer_load_dwordx4 v2, s[20:23], s63 offen lds
    s_add_u32 m0, s66, 24576
    s_nop 0
    buffer_load_dwordx4 v3, s[24:27], s64 offen lds
    s_add_u32 m0, s66, 25600
    s_nop 0
    buffer_load_dwordx4 v3, s[24:27], s65 offen lds
    s_add_u32 s62, s62, 262144
    s_add_u32 s63, s63, 262144
    s_add_u32 s64, s64, 0x10000
    s_add_u32 s65, s65, 0x10000
    s_add_u32 m0, s66, 32768
    s_nop 0
    buffer_load_dwordx4 v2, s[20:23], s62 offen lds
    s_add_u32 m0, s66, 33792
    s_nop 0
    buffer_load_dwordx4 v2, s[20:23], s63 offen lds
    s_add_u32 m0, s66, 40960
    s_nop 0
    buffer_load_dwordx4 v3, s[24:27], s64 offen lds
    s_add_u32 m0, s66, 41984
    s_nop 0
    buffer_load_dwordx4 v3, s[24:27], s65 offen lds
    s_add_u32 s62, s62, 262144
    s_add_u32 s63, s63, 262144
    s_add_u32 s64, s64, 0x10000
    s_add_u32 s65, s65, 0x10000
    s_waitcnt vmcnt(8)
    s_barrier
    s_add_u32 m0, s66, 49152
    s_nop 0
    buffer_load_dwordx4 v2, s[20:23], s62 offen lds
    s_add_u32 m0, s66, 50176
    s_nop 0
    buffer_load_dwordx4 v2, s[20:23], s63 offen lds
    s_add_u32 m0, s66, 57344
    s_nop 0
    buffer_load_dwordx4 v3, s[24:27], s64 offen lds
    s_add_u32 m0, s66, 58368
    s_nop 0
    buffer_load_dwordx4 v3, s[24:27], s65 offen lds
    s_add_u32 s62, s62, 262144
    s_add_u32 s63, s63, 262144
    s_add_u32 s64, s64, 0x10000
    s_add_u32 s65, s65, 0x10000
    ds_read_b64_tr_b16 v[32:33], v4 offset:0
    ds_read_b64_tr_b16 v[34:35], v4 offset:512
    ds_read_b128 v[48:51], v5 offset:0
    ds_read_b64_tr_b16 v[36:37], v4 offset:2048
    ds_read_b64_tr_b16 v[38:39], v4 offset:2560
    ds_read_b128 v[52:55], v5 offset:2048
    ds_read_b64_tr_b16 v[40:41], v4 offset:4096
    ds_read_b64_tr_b16 v[42:43], v4 offset:4608
    ds_read_b128 v[56:59], v5 offset:4096
    ds_read_b64_tr_b16 v[44:45], v4 offset:6144
    ds_read_b64_tr_b16 v[46:47], v4 offset:6656
    ds_read_b128 v[60:63], v5 offset:6144
    s_waitcnt lgkmcnt(9)
    v_mfma_f32_32x32x16_bf16 v[16:31], v[32:35], v[48:51], v[16:31]
    s_waitcnt lgkmcnt(6)
    v_mfma_f32_32x32x16_bf16 v[16:31], v[36:39], v[52:55], v[16:31]
    s_waitcnt lgkmcnt(3)
    v_mfma_f32_32x32x16_bf16 v[16:31], v[40:43], v[56:59], v[16:31]
    s_waitcnt lgkmcnt(0)
    v_mfma_f32_32x32x16_bf16 v[16:31], v[44:47], v[60:63], v[16:31]
    s_waitcnt vmcnt(8)
    s_barrier
    s_add_u32 m0, s66, 0
    s_nop 0
    buffer_load_dwordx4 v2, s[20:23], s62 offen lds
    s_add_u32 m0, s66, 1024
    s_nop 0
    buffer_load_dwordx4 v2, s[20:23], s63 offen lds
    s_add_u32 m0, s66, 8192
    s_nop 0
    buffer_load_dwordx4 v3, s[24:27], s64 offen lds
    s_add_u32 m0, s66, 9216
    s_nop 0
    buffer_load_dwordx4 v3, s[24:27], s65 offen lds
    s_add_u32 s62, s62, 262144
    s_add_u32 s63, s63, 262144
    s_add_u32 s64, s64, 0x10000
    s_add_u32 s65, s65, 0x10000
    ds_read_b64_tr_b16 v[32:33], v4 offset:16384
    ds_read_b64_tr_b16 v[34:35], v4 offset:16896
    ds_read_b128 v[48:51], v5 offset:16384
    ds_read_b64_tr_b16 v[36:37], v4 offset:18432
    ds_read_b64_tr_b16 v[38:39], v4 offset:18944
    ds_read_b128 v[52:55], v5 offset:18432
    ds_read_b64_tr_b16 v[40:41], v4 offset:20480
    ds_read_b64_tr_b16 v[42:43], v4 offset:20992
    ds_read_b128 v[56:59], v5 offset:20480
    ds_read_b64_tr_b16 v[44:45], v4 offset:22528
    ds_read_b64_tr_b16 v[46:47], v4 offset:23040
    ds_read_b128 v[60:63], v5 offset:22528
    s_waitcnt lgkmcnt(9)
    v_mfma_f32_32x32x16_bf16 v[16:31], v[32:35], v[48:51], v[16:31]
    s_waitcnt lgkmcnt(6)
    v_mfma_f32_32x32x16_bf16 v[16:31], v[36:39], v[52:55], v[16:31]
    s_waitcnt lgkmcnt(3)
    v_mfma_f32_32x32x16_bf16 v[16:31], v[40:43], v[56:59], v[16:31]
    s_waitcnt lgkmcnt(0)
    v_mfma_f32_32x32x16_bf16 v[16:31], v[44:47], v[60:63], v[16:31]
    s_waitcnt vmcnt(8)
    s_barrier
    s_add_u32 m0, s66, 16384
    s_nop 0
    buffer_load_dwordx4 v2, s[20:23], s62 offen lds
    s_add_u32 m0, s66, 17408
    s_nop 0
    buffer_load_dwordx4 v2, s[20:23], s63 offen lds
    s_add_u32 m0, s66, 24576
    s_nop 0
    buffer_load_dwordx4 v3, s[24:27], s64 offen lds
    s_add_u32 m0, s66, 25600
    s_nop 0
    buffer_load_dwordx4 v3, s[24:27], s65 offen lds
    s_add_u32 s62, s62, 262144
    s_add_u32 s63, s63, 262144
    s_add_u32 s64, s64, 0x10000
    s_add_u32 s65, s65, 0x10000
    ds_read_b64_tr_b16 v[32:33], v4 offset:32768
    ds_read_b64_tr_b16 v[34:35], v4 offset:33280
    ds_read_b128 v[48:51], v5 offset:32768
    ds_read_b64_tr_b16 v[36:37], v4 offset:34816
    ds_read_b64_tr_b16 v[38:39], v4 offset:35328
    ds_read_b128 v[52:55], v5 offset:34816
    ds_read_b64_tr_b16 v[40:41], v4 offset:36864
    ds_read_b64_tr_b16 v[42:43], v4 offset:37376
    ds_read_b128 v[56:59], v5 offset:36864
    ds_read_b64_tr_b16 v[44:45], v4 offset:38912
    ds_read_b64_tr_b16 v[46:47], v4 offset:39424
    ds_read_b128 v[60:63], v5 offset:38912
    s_waitcnt lgkmcnt(9)
    v_mfma_f32_32x32x16_bf16 v[16:31], v[32:35], v[48:51], v[16:31]
    s_waitcnt lgkmcnt(6)
    v_mfma_f32_32x32x16_bf16 v[16:31], v[36:39], v[52:55], v[16:31]
    s_waitcnt lgkmcnt(3)
    v_mfma_f32_32x32x16_bf16 v[16:31], v[40:43], v[56:59], v[16:31]
    s_waitcnt lgkmcnt(0)
    v_mfma_f32_32x32x16_bf16 v[16:31], v[44:47], v[60:63], v[16:31]
    s_waitcnt vmcnt(8)
    s_barrier
    s_add_u32 m0, s66, 32768
    s_nop 0
    buffer_load_dwordx4 v2, s[20:23], s62 offen lds
    s_add_u32 m0, s66, 33792
    s_nop 0
    buffer_load_dwordx4 v2, s[20:23], s63 offen lds
    s_add_u32 m0, s66, 40960
    s_nop 0
    buffer_load_dwordx4 v3, s[24:27], s64 offen lds
    s_add_u32 m0, s66, 41984
    s_nop 0
    buffer_load_dwordx4 v3, s[24:27], s65 offen lds
    s_add_u32 s62, s62, 262144
    s_add_u32 s63, s63, 262144
    s_add_u32 s64, s64, 0x10000
    s_add_u32 s65, s65, 0x10000
    ds_read_b64_tr_b16 v[32:33], v4 offset:49152
    ds_read_b64_tr_b16 v[34:35], v4 offset:49664
    ds_read_b128 v[48:51], v5 offset:49152
    ds_read_b64_tr_b16 v[36:37], v4 offset:51200
    ds_read_b64_tr_b16 v[38:39], v4 offset:51712
    ds_read_b128 v[52:55], v5 offset:51200
    ds_read_b64_tr_b16 v[40:41], v4 offset:53248
    ds_read_b64_tr_b16 v[42:43], v4 offset:53760
    ds_read_b128 v[56:59], v5 offset:53248
    ds_read_b64_tr_b16 v[44:45], v4 offset:55296
    ds_read_b64_tr_b16 v[46:47], v4 offset:55808
    ds_read_b128 v[60:63], v5 offset:55296
    s_waitcnt lgkmcnt(9)
    v_mfma_f32_32x32x16_bf16 v[16:31], v[32:35], v[48:51], v[16:31]
    s_waitcnt lgkmcnt(6)
    v_mfma_f32_32x32x16_bf16 v[16:31], v[36:39], v[52:55], v[16:31]
    s_waitcnt lgkmcnt(3)
    v_mfma_f32_32x32x16_bf16 v[16:31], v[40:43], v[56:59], v[16:31]
    s_waitcnt lgkmcnt(0)
    v_mfma_f32_32x32x16_bf16 v[16:31], v[44:47], v[60:63], v[16:31]
    s_waitcnt vmcnt(8)
    s_barrier
    s_add_u32 m0, s66, 49152
    s_nop 0
    buffer_load_dwordx4 v2, s[20:23], s62 offen lds
    s_add_u32 m0, s66, 50176
    s_nop 0
    buffer_load_dwordx4 v2, s[20:23], s63 offen lds
    s_add_u32 m0, s66, 57344
    s_nop 0
    buffer_load_dwordx4 v3, s[24:27], s64 offen lds
    s_add_u32 m0, s66, 58368
    s_nop 0
    buffer_load_dwordx4 v3, s[24:27], s65 offen lds
    s_add_u32 s62, s62, 262144
    s_add_u32 s63, s63, 262144
    s_add_u32 s64, s64, 0x10000
    s_add_u32 s65, s65, 0x10000
    ds_read_b64_tr_b16 v[32:33], v4 offset:0
    ds_read_b64_tr_b16 v[34:35], v4 offset:512
    ds_read_b128 v[48:51], v5 offset:0
    ds_read_b64_tr_b16 v[36:37], v4 offset:2048
    ds_read_b64_tr_b16 v[38:39], v4 offset:2560
    ds_read_b128 v[52:55], v5 offset:2048
    ds_read_b64_tr_b16 v[40:41], v4 offset:4096
    ds_read_b64_tr_b16 v[42:43], v4 offset:4608
    ds_read_b128 v[56:59], v5 offset:4096
    ds_read_b64_tr_b16 v[44:45], v4 offset:6144
    ds_read_b64_tr_b16 v[46:47], v4 offset:6656
    ds_read_b128 v[60:63], v5 offset:6144
    s_waitcnt lgkmcnt(9)
    v_mfma_f32_32x32x16_bf16 v[16:31], v[32:35], v[48:51], v[16:31]
    s_waitcnt lgkmcnt(6)
    v_mfma_f32_32x32x16_bf16 v[16:31], v[36:39], v[52:55], v[16:31]
    s_waitcnt lgkmcnt(3)
    v_mfma_f32_32x32x16_bf16 v[16:31], v[40:43], v[56:59], v[16:31]
    s_waitcnt lgkmcnt(0)
    v_mfma_f32_32x32x16_bf16 v[16:31], v[44:47], v[60:63], v[16:31]
    s_waitcnt vmcnt(8)
    s_barrier
    s_add_u32 m0, s66, 0
    s_nop 0
    buffer_load_dwordx4 v2, s[20:23], s62 offen lds
    s_add_u32 m0, s66, 1024
    s_nop 0
    buffer_load_dwordx4 v2, s[20:23], s63 offen lds
    s_add_u32 m0, s66, 8192
    s_nop 0
    buffer_load_dwordx4 v3, s[24:27], s64 offen lds
    s_add_u32 m0, s66, 9216
    s_nop 0
    buffer_load_dwordx4 v3, s[24:27], s65 offen lds
    s_add_u32 s62, s62, 262144
    s_add_u32 s63, s63, 262144
    s_add_u32 s64, s64, 0x10000
    s_add_u32 s65, s65, 0x10000
    ds_read_b64_tr_b16 v[32:33], v4 offset:16384
    ds_read_b64_tr_b16 v[34:35], v4 offset:16896
    ds_read_b128 v[48:51], v5 offset:16384
    ds_read_b64_tr_b16 v[36:37], v4 offset:18432
    ds_read_b64_tr_b16 v[38:39], v4 offset:18944
    ds_read_b128 v[52:55], v5 offset:18432
    ds_read_b64_tr_b16 v[40:41], v4 offset:20480
    ds_read_b64_tr_b16 v[42:43], v4 offset:20992
    ds_read_b128 v[56:59], v5 offset:20480
    ds_read_b64_tr_b16 v[44:45], v4 offset:22528
    ds_read_b64_tr_b16 v[46:47], v4 offset:23040
    ds_read_b128 v[60:63], v5 offset:22528
    s_waitcnt lgkmcnt(9)
    v_mfma_f32_32x32x16_bf16 v[16:31], v[32:35], v[48:51], v[16:31]
    s_waitcnt lgkmcnt(6)
    v_mfma_f32_32x32x16_bf16 v[16:31], v[36:39], v[52:55], v[16:31]
    s_waitcnt lgkmcnt(3)
    v_mfma_f32_32x32x16_bf16 v[16:31], v[40:43], v[56:59], v[16:31]
    s_waitcnt lgkmcnt(0)
    v_mfma_f32_32x32x16_bf16 v[16:31], v[44:47], v[60:63], v[16:31]
    s_waitcnt vmcnt(8)
    s_barrier
    s_add_u32 m0, s66, 16384
    s_nop 0
    buffer_load_dwordx4 v2, s[20:23], s62 offen lds
    s_add_u32 m0, s66, 17408
    s_nop 0
    buffer_load_dwordx4 v2, s[20:23], s63 offen lds
    s_add_u32 m0, s66, 24576
    s_nop 0
    buffer_load_dwordx4 v3, s[24:27], s64 offen lds
    s_add_u32 m0, s66, 25600
    s_nop 0
    buffer_load_dwordx4 v3, s[24:27], s65 offen lds
    s_add_u32 s62, s62, 262144
    s_add_u32 s63, s63, 262144
    s_add_u32 s64, s64, 0x10000
    s_add_u32 s65, s65, 0x10000
    ds_read_b64_tr_b16 v[32:33], v4 offset:32768
    ds_read_b64_tr_b16 v[34:35], v4 offset:33280
    ds_read_b128 v[48:51], v5 offset:32768
    ds_read_b64_tr_b16 v[36:37], v4 offset:34816
    ds_read_b64_tr_b16 v[38:39], v4 offset:35328
    ds_read_b128 v[52:55], v5 offset:34816
    ds_read_b64_tr_b16 v[40:41], v4 offset:36864
    ds_read_b64_tr_b16 v[42:43], v4 offset:37376
    ds_read_b128 v[56:59], v5 offset:36864
    ds_read_b64_tr_b16 v[44:45], v4 offset:38912
    ds_read_b64_tr_b16 v[46:47], v4 offset:39424
    ds_read_b128 v[60:63], v5 offset:38912
    s_waitcnt lgkmcnt(9)
    v_mfma_f32_32x32x16_bf16 v[16:31], v[32:35], v[48:51], v[16:31]
    s_waitcnt lgkmcnt(6)
    v_mfma_f32_32x32x16_bf16 v[16:31], v[36:39], v[52:55], v[16:31]
    s_waitcnt lgkmcnt(3)
    v_mfma_f32_32x32x16_bf16 v[16:31], v[40:43], v[56:59], v[16:31]
    s_waitcnt lgkmcnt(0)
    v_mfma_f32_32x32x16_bf16 v[16:31], v[44:47], v[60:63], v[16:31]
    s_waitcnt vmcnt(8)
    s_barrier
    s_add_u32 m0, s66, 32768
    s_nop 0
    buffer_load_dwordx4 v2, s[20:23], s62 offen lds
    s_add_u32 m0, s66, 33792
    s_nop 0
    buffer_load_dwordx4 v2, s[20:23], s63 offen lds
    s_add_u32 m0, s66, 40960
    s_nop 0
    buffer_load_dwordx4 v3, s[24:27], s64 offen lds
    s_add_u32 m0, s66, 41984
    s_nop 0
    buffer_load_dwordx4 v3, s[24:27], s65 offen lds
    s_add_u32 s62, s62, 262144
    s_add_u32 s63, s63, 262144
    s_add_u32 s64, s64, 0x10000
    s_add_u32 s65, s65, 0x10000
    ds_read_b64_tr_b16 v[32:33], v4 offset:49152
    ds_read_b64_tr_b16 v[34:35], v4 offset:49664
    ds_read_b128 v[48:51], v5 offset:49152
    ds_read_b64_tr_b16 v[36:37], v4 offset:51200
    ds_read_b64_tr_b16 v[38:39], v4 offset:51712
    ds_read_b128 v[52:55], v5 offset:51200
    ds_read_b64_tr_b16 v[40:41], v4 offset:53248
    ds_read_b64_tr_b16 v[42:43], v4 offset:53760
    ds_read_b128 v[56:59], v5 offset:53248
    ds_read_b64_tr_b16 v[44:45], v4 offset:55296
    ds_read_b64_tr_b16 v[46:47], v4 offset:55808
    ds_read_b128 v[60:63], v5 offset:55296
    s_waitcnt lgkmcnt(9)
    v_mfma_f32_32x32x16_bf16 v[16:31], v[32:35], v[48:51], v[16:31]
    s_waitcnt lgkmcnt(6)
    v_mfma_f32_32x32x16_bf16 v[16:31], v[36:39], v[52:55], v[16:31]
    s_waitcnt lgkmcnt(3)
    v_mfma_f32_32x32x16_bf16 v[16:31], v[40:43], v[56:59], v[16:31]
    s_waitcnt lgkmcnt(0)
    v_mfma_f32_32x32x16_bf16 v[16:31], v[44:47], v[60:63], v[16:31]
    s_waitcnt vmcnt(8)
    s_barrier
    s_add_u32 m0, s66, 49152
    s_nop 0
    buffer_load_dwordx4 v2, s[20:23], s62 offen lds
    s_add_u32 m0, s66, 50176
    s_nop 0
    buffer_load_dwordx4 v2, s[20:23], s63 offen lds
    s_add_u32 m0, s66, 57344
    s_nop 0
    buffer_load_dwordx4 v3, s[24:27], s64 offen lds
    s_add_u32 m0, s66, 58368
    s_nop 0
    buffer_load_dwordx4 v3, s[24:27], s65 offen lds
    s_add_u32 s62, s62, 262144
    s_add_u32 s63, s63, 262144
    s_add_u32 s64, s64, 0x10000
    s_add_u32 s65, s65, 0x10000
    ds_read_b64_tr_b16 v[32:33], v4 offset:0
    ds_read_b64_tr_b16 v[34:35], v4 offset:512
    ds_read_b128 v[48:51], v5 offset:0
    ds_read_b64_tr_b16 v[36:37], v4 offset:2048
    ds_read_b64_tr_b16 v[38:39], v4 offset:2560
    ds_read_b128 v[52:55], v5 offset:2048
    ds_read_b64_tr_b16 v[40:41], v4 offset:4096
    ds_read_b64_tr_b16 v[42:43], v4 offset:4608
    ds_read_b128 v[56:59], v5 offset:4096
    ds_read_b64_tr_b16 v[44:45], v4 offset:6144
    ds_read_b64_tr_b16 v[46:47], v4 offset:6656
    ds_read_b128 v[60:63], v5 offset:6144
    s_waitcnt lgkmcnt(9)
    v_mfma_f32_32x32x16_bf16 v[16:31], v[32:35], v[48:51], v[16:31]
    s_waitcnt lgkmcnt(6)
    v_mfma_f32_32x32x16_bf16 v[16:31], v[36:39], v[52:55], v[16:31]
    s_waitcnt lgkmcnt(3)
    v_mfma_f32_32x32x16_bf16 v[16:31], v[40:43], v[56:59], v[16:31]
    s_waitcnt lgkmcnt(0)
    v_mfma_f32_32x32x16_bf16 v[16:31], v[44:47], v[60:63], v[16:31]
    s_waitcnt vmcnt(8)
    s_barrier
    s_add_u32 m0, s66, 0
    s_nop 0
    buffer_load_dwordx4 v2, s[20:23], s62 offen lds
    s_add_u32 m0, s66, 1024
    s_nop 0
    buffer_load_dwordx4 v2, s[20:23], s63 offen lds
    s_add_u32 m0, s66, 8192
    s_nop 0
    buffer_load_dwordx4 v3, s[24:27], s64 offen lds
    s_add_u32 m0, s66, 9216
    s_nop 0
    buffer_load_dwordx4 v3, s[24:27], s65 offen lds
    s_add_u32 s62, s62, 262144
    s_add_u32 s63, s63, 262144
    s_add_u32 s64, s64, 0x10000
    s_add_u32 s65, s65, 0x10000
    ds_read_b64_tr_b16 v[32:33], v4 offset:16384
    ds_read_b64_tr_b16 v[34:35], v4 offset:16896
    ds_read_b128 v[48:51], v5 offset:16384
    ds_read_b64_tr_b16 v[36:37], v4 offset:18432
    ds_read_b64_tr_b16 v[38:39], v4 offset:18944
    ds_read_b128 v[52:55], v5 offset:18432
    ds_read_b64_tr_b16 v[40:41], v4 offset:20480
    ds_read_b64_tr_b16 v[42:43], v4 offset:20992
    ds_read_b128 v[56:59], v5 offset:20480
    ds_read_b64_tr_b16 v[44:45], v4 offset:22528
    ds_read_b64_tr_b16 v[46:47], v4 offset:23040
    ds_read_b128 v[60:63], v5 offset:22528
    s_waitcnt lgkmcnt(9)
    v_mfma_f32_32x32x16_bf16 v[16:31], v[32:35], v[48:51], v[16:31]
    s_waitcnt lgkmcnt(6)
    v_mfma_f32_32x32x16_bf16 v[16:31], v[36:39], v[52:55], v[16:31]
    s_waitcnt lgkmcnt(3)
    v_mfma_f32_32x32x16_bf16 v[16:31], v[40:43], v[56:59], v[16:31]
    s_waitcnt lgkmcnt(0)
    v_mfma_f32_32x32x16_bf16 v[16:31], v[44:47], v[60:63], v[16:31]
    s_waitcnt vmcnt(8)
    s_barrier
    s_add_u32 m0, s66, 16384
    s_nop 0
    buffer_load_dwordx4 v2, s[20:23], s62 offen lds
    s_add_u32 m0, s66, 17408
    s_nop 0
    buffer_load_dwordx4 v2, s[20:23], s63 offen lds
    s_add_u32 m0, s66, 24576
    s_nop 0
    buffer_load_dwordx4 v3, s[24:27], s64 offen lds
    s_add_u32 m0, s66, 25600
    s_nop 0
    buffer_load_dwordx4 v3, s[24:27], s65 offen lds
    s_add_u32 s62, s62, 262144
    s_add_u32 s63, s63, 262144
    s_add_u32 s64, s64, 0x10000
    s_add_u32 s65, s65, 0x10000
    ds_read_b64_tr_b16 v[32:33], v4 offset:32768
    ds_read_b64_tr_b16 v[34:35], v4 offset:33280
    ds_read_b128 v[48:51], v5 offset:32768
    ds_read_b64_tr_b16 v[36:37], v4 offset:34816
    ds_read_b64_tr_b16 v[38:39], v4 offset:35328
    ds_read_b128 v[52:55], v5 offset:34816
    ds_read_b64_tr_b16 v[40:41], v4 offset:36864
    ds_read_b64_tr_b16 v[42:43], v4 offset:37376
    ds_read_b128 v[56:59], v5 offset:36864
    ds_read_b64_tr_b16 v[44:45], v4 offset:38912
    ds_read_b64_tr_b16 v[46:47], v4 offset:39424
    ds_read_b128 v[60:63], v5 offset:38912
    s_waitcnt lgkmcnt(9)
    v_mfma_f32_32x32x16_bf16 v[16:31], v[32:35], v[48:51], v[16:31]
    s_waitcnt lgkmcnt(6)
    v_mfma_f32_32x32x16_bf16 v[16:31], v[36:39], v[52:55], v[16:31]
    s_waitcnt lgkmcnt(3)
    v_mfma_f32_32x32x16_bf16 v[16:31], v[40:43], v[56:59], v[16:31]
    s_waitcnt lgkmcnt(0)
    v_mfma_f32_32x32x16_bf16 v[16:31], v[44:47], v[60:63], v[16:31]
    s_waitcnt vmcnt(8)
    s_barrier
    s_add_u32 m0, s66, 32768
    s_nop 0
    buffer_load_dwordx4 v2, s[20:23], s62 offen lds
    s_add_u32 m0, s66, 33792
    s_nop 0
    buffer_load_dwordx4 v2, s[20:23], s63 offen lds
    s_add_u32 m0, s66, 40960
    s_nop 0
    buffer_load_dwordx4 v3, s[24:27], s64 offen lds
    s_add_u32 m0, s66, 41984
    s_nop 0
    buffer_load_dwordx4 v3, s[24:27], s65 offen lds
    s_add_u32 s62, s62, 262144
    s_add_u32 s63, s63, 262144
    s_add_u32 s64, s64, 0x10000
    s_add_u32 s65, s65, 0x10000
    ds_read_b64_tr_b16 v[32:33], v4 offset:49152
    ds_read_b64_tr_b16 v[34:35], v4 offset:49664
    ds_read_b128 v[48:51], v5 offset:49152
    ds_read_b64_tr_b16 v[36:37], v4 offset:51200
    ds_read_b64_tr_b16 v[38:39], v4 offset:51712
    ds_read_b128 v[52:55], v5 offset:51200
    ds_read_b64_tr_b16 v[40:41], v4 offset:53248
    ds_read_b64_tr_b16 v[42:43], v4 offset:53760
    ds_read_b128 v[56:59], v5 offset:53248
    ds_read_b64_tr_b16 v[44:45], v4 offset:55296
    ds_read_b64_tr_b16 v[46:47], v4 offset:55808
    ds_read_b128 v[60:63], v5 offset:55296
    s_waitcnt lgkmcnt(9)
    v_mfma_f32_32x32x16_bf16 v[16:31], v[32:35], v[48:51], v[16:31]
    s_waitcnt lgkmcnt(6)
    v_mfma_f32_32x32x16_bf16 v[16:31], v[36:39], v[52:55], v[16:31]
    s_waitcnt lgkmcnt(3)
    v_mfma_f32_32x32x16_bf16 v[16:31], v[40:43], v[56:59], v[16:31]
    s_waitcnt lgkmcnt(0)
    v_mfma_f32_32x32x16_bf16 v[16:31], v[44:47], v[60:63], v[16:31]
    s_waitcnt vmcnt(8)
    s_barrier
    s_add_u32 m0, s66, 49152
    s_nop 0
    buffer_load_dwordx4 v2, s[20:23], s62 offen lds
    s_add_u32 m0, s66, 50176
    s_nop 0
    buffer_load_dwordx4 v2, s[20:23], s63 offen lds
    s_add_u32 m0, s66, 57344
    s_nop 0
    buffer_load_dwordx4 v3, s[24:27], s64 offen lds
    s_add_u32 m0, s66, 58368
    s_nop 0
    buffer_load_dwordx4 v3, s[24:27], s65 offen lds
    s_add_u32 s62, s62, 262144
    s_add_u32 s63, s63, 262144
    s_add_u32 s64, s64, 0x10000
    s_add_u32 s65, s65, 0x10000
    ds_read_b64_tr_b16 v[32:33], v4 offset:0
    ds_read_b64_tr_b16 v[34:35], v4 offset:512
    ds_read_b128 v[48:51], v5 offset:0
    ds_read_b64_tr_b16 v[36:37], v4 offset:2048
    ds_read_b64_tr_b16 v[38:39], v4 offset:2560
    ds_read_b128 v[52:55], v5 offset:2048
    ds_read_b64_tr_b16 v[40:41], v4 offset:4096
    ds_read_b64_tr_b16 v[42:43], v4 offset:4608
    ds_read_b128 v[56:59], v5 offset:4096
    ds_read_b64_tr_b16 v[44:45], v4 offset:6144
    ds_read_b64_tr_b16 v[46:47], v4 offset:6656
    ds_read_b128 v[60:63], v5 offset:6144
    s_waitcnt lgkmcnt(9)
    v_mfma_f32_32x32x16_bf16 v[16:31], v[32:35], v[48:51], v[16:31]
    s_waitcnt lgkmcnt(6)
    v_mfma_f32_32x32x16_bf16 v[16:31], v[36:39], v[52:55], v[16:31]
    s_waitcnt lgkmcnt(3)
    v_mfma_f32_32x32x16_bf16 v[16:31], v[40:43], v[56:59], v[16:31]
    s_waitcnt lgkmcnt(0)
    v_mfma_f32_32x32x16_bf16 v[16:31], v[44:47], v[60:63], v[16:31]
    s_waitcnt vmcnt(8)
    s_barrier
    s_add_u32 m0, s66, 0
    s_nop 0
    buffer_load_dwordx4 v2, s[20:23], s62 offen lds
    s_add_u32 m0, s66, 1024
    s_nop 0
    buffer_load_dwordx4 v2, s[20:23], s63 offen lds
    s_add_u32 m0, s66, 8192
    s_nop 0
    buffer_load_dwordx4 v3, s[24:27], s64 offen lds
    s_add_u32 m0, s66, 9216
    s_nop 0
    buffer_load_dwordx4 v3, s[24:27], s65 offen lds
    s_add_u32 s62, s62, 262144
    s_add_u32 s63, s63, 262144
    s_add_u32 s64, s64, 0x10000
    s_add_u32 s65, s65, 0x10000
    ds_read_b64_tr_b16 v[32:33], v4 offset:16384
    ds_read_b64_tr_b16 v[34:35], v4 offset:16896
    ds_read_b128 v[48:51], v5 offset:16384
    ds_read_b64_tr_b16 v[36:37], v4 offset:18432
    ds_read_b64_tr_b16 v[38:39], v4 offset:18944
    ds_read_b128 v[52:55], v5 offset:18432
    ds_read_b64_tr_b16 v[40:41], v4 offset:20480
    ds_read_b64_tr_b16 v[42:43], v4 offset:20992
    ds_read_b128 v[56:59], v5 offset:20480
    ds_read_b64_tr_b16 v[44:45], v4 offset:22528
    ds_read_b64_tr_b16 v[46:47], v4 offset:23040
    ds_read_b128 v[60:63], v5 offset:22528
    s_waitcnt lgkmcnt(9)
    v_mfma_f32_32x32x16_bf16 v[16:31], v[32:35], v[48:51], v[16:31]
    s_waitcnt lgkmcnt(6)
    v_mfma_f32_32x32x16_bf16 v[16:31], v[36:39], v[52:55], v[16:31]
    s_waitcnt lgkmcnt(3)
    v_mfma_f32_32x32x16_bf16 v[16:31], v[40:43], v[56:59], v[16:31]
    s_waitcnt lgkmcnt(0)
    v_mfma_f32_32x32x16_bf16 v[16:31], v[44:47], v[60:63], v[16:31]
    s_waitcnt vmcnt(8)
    s_barrier
    s_add_u32 m0, s66, 16384
    s_nop 0
    buffer_load_dwordx4 v2, s[20:23], s62 offen lds
    s_add_u32 m0, s66, 17408
    s_nop 0
    buffer_load_dwordx4 v2, s[20:23], s63 offen lds
    s_add_u32 m0, s66, 24576
    s_nop 0
    buffer_load_dwordx4 v3, s[24:27], s64 offen lds
    s_add_u32 m0, s66, 25600
    s_nop 0
    buffer_load_dwordx4 v3, s[24:27], s65 offen lds
    s_add_u32 s62, s62, 262144
    s_add_u32 s63, s63, 262144
    s_add_u32 s64, s64, 0x10000
    s_add_u32 s65, s65, 0x10000
    ds_read_b64_tr_b16 v[32:33], v4 offset:32768
    ds_read_b64_tr_b16 v[34:35], v4 offset:33280
    ds_read_b128 v[48:51], v5 offset:32768
    ds_read_b64_tr_b16 v[36:37], v4 offset:34816
    ds_read_b64_tr_b16 v[38:39], v4 offset:35328
    ds_read_b128 v[52:55], v5 offset:34816
    ds_read_b64_tr_b16 v[40:41], v4 offset:36864
    ds_read_b64_tr_b16 v[42:43], v4 offset:37376
    ds_read_b128 v[56:59], v5 offset:36864
    ds_read_b64_tr_b16 v[44:45], v4 offset:38912
    ds_read_b64_tr_b16 v[46:47], v4 offset:39424
    ds_read_b128 v[60:63], v5 offset:38912
    s_waitcnt lgkmcnt(9)
    v_mfma_f32_32x32x16_bf16 v[16:31], v[32:35], v[48:51], v[16:31]
    s_waitcnt lgkmcnt(6)
    v_mfma_f32_32x32x16_bf16 v[16:31], v[36:39], v[52:55], v[16:31]
    s_waitcnt lgkmcnt(3)
    v_mfma_f32_32x32x16_bf16 v[16:31], v[40:43], v[56:59], v[16:31]
    s_waitcnt lgkmcnt(0)
    v_mfma_f32_32x32x16_bf16 v[16:31], v[44:47], v[60:63], v[16:31]
    s_waitcnt vmcnt(8)
    s_barrier
    s_add_u32 m0, s66, 32768
    s_nop 0
    buffer_load_dwordx4 v2, s[20:23], s62 offen lds
    s_add_u32 m0, s66, 33792
    s_nop 0
    buffer_load_dwordx4 v2, s[20:23], s63 offen lds
    s_add_u32 m0, s66, 40960
    s_nop 0
    buffer_load_dwordx4 v3, s[24:27], s64 offen lds
    s_add_u32 m0, s66, 41984
    s_nop 0
    buffer_load_dwordx4 v3, s[24:27], s65 offen lds
    s_add_u32 s62, s62, 262144
    s_add_u32 s63, s63, 262144
    s_add_u32 s64, s64, 0x10000
    s_add_u32 s65, s65, 0x10000
    ds_read_b64_tr_b16 v[32:33], v4 offset:49152
    ds_read_b64_tr_b16 v[34:35], v4 offset:49664
    ds_read_b128 v[48:51], v5 offset:49152
    ds_read_b64_tr_b16 v[36:37], v4 offset:51200
    ds_read_b64_tr_b16 v[38:39], v4 offset:51712
    ds_read_b128 v[52:55], v5 offset:51200
    ds_read_b64_tr_b16 v[40:41], v4 offset:53248
    ds_read_b64_tr_b16 v[42:43], v4 offset:53760
    ds_read_b128 v[56:59], v5 offset:53248
    ds_read_b64_tr_b16 v[44:45], v4 offset:55296
    ds_read_b64_tr_b16 v[46:47], v4 offset:55808
    ds_read_b128 v[60:63], v5 offset:55296
    s_waitcnt lgkmcnt(9)
    v_mfma_f32_32x32x16_bf16 v[16:31], v[32:35], v[48:51], v[16:31]
    s_waitcnt lgkmcnt(6)
    v_mfma_f32_32x32x16_bf16 v[16:31], v[36:39], v[52:55], v[16:31]
    s_waitcnt lgkmcnt(3)
    v_mfma_f32_32x32x16_bf16 v[16:31], v[40:43], v[56:59], v[16:31]
    s_waitcnt lgkmcnt(0)
    v_mfma_f32_32x32x16_bf16 v[16:31], v[44:47], v[60:63], v[16:31]
    s_waitcnt vmcnt(8)
    s_barrier
    s_add_u32 m0, s66, 49152
    s_nop 0
    buffer_load_dwordx4 v2, s[20:23], s62 offen lds
    s_add_u32 m0, s66, 50176
    s_nop 0
    buffer_load_dwordx4 v2, s[20:23], s63 offen lds
    s_add_u32 m0, s66, 57344
    s_nop 0
    buffer_load_dwordx4 v3, s[24:27], s64 offen lds
    s_add_u32 m0, s66, 58368
    s_nop 0
    buffer_load_dwordx4 v3, s[24:27], s65 offen lds
    s_add_u32 s62, s62, 262144
    s_add_u32 s63, s63, 262144
    s_add_u32 s64, s64, 0x10000
    s_add_u32 s65, s65, 0x10000
    ds_read_b64_tr_b16 v[32:33], v4 offset:0
    ds_read_b64_tr_b16 v[34:35], v4 offset:512
    ds_read_b128 v[48:51], v5 offset:0
    ds_read_b64_tr_b16 v[36:37], v4 offset:2048
    ds_read_b64_tr_b16 v[38:39], v4 offset:2560
    ds_read_b128 v[52:55], v5 offset:2048
    ds_read_b64_tr_b16 v[40:41], v4 offset:4096
    ds_read_b64_tr_b16 v[42:43], v4 offset:4608
    ds_read_b128 v[56:59], v5 offset:4096
    ds_read_b64_tr_b16 v[44:45], v4 offset:6144
    ds_read_b64_tr_b16 v[46:47], v4 offset:6656
    ds_read_b128 v[60:63], v5 offset:6144
    s_waitcnt lgkmcnt(9)
    v_mfma_f32_32x32x16_bf16 v[16:31], v[32:35], v[48:51], v[16:31]
    s_waitcnt lgkmcnt(6)
    v_mfma_f32_32x32x16_bf16 v[16:31], v[36:39], v[52:55], v[16:31]
    s_waitcnt lgkmcnt(3)
    v_mfma_f32_32x32x16_bf16 v[16:31], v[40:43], v[56:59], v[16:31]
    s_waitcnt lgkmcnt(0)
    v_mfma_f32_32x32x16_bf16 v[16:31], v[44:47], v[60:63], v[16:31]
    s_waitcnt vmcnt(8)
    s_barrier
    s_add_u32 m0, s66, 0
    s_nop 0
    buffer_load_dwordx4 v2, s[20:23], s62 offen lds
    s_add_u32 m0, s66, 1024
    s_nop 0
    buffer_load_dwordx4 v2, s[20:23], s63 offen lds
    s_add_u32 m0, s66, 8192
    s_nop 0
    buffer_load_dwordx4 v3, s[24:27], s64 offen lds
    s_add_u32 m0, s66, 9216
    s_nop 0
    buffer_load_dwordx4 v3, s[24:27], s65 offen lds
    s_add_u32 s62, s62, 262144
    s_add_u32 s63, s63, 262144
    s_add_u32 s64, s64, 0x10000
    s_add_u32 s65, s65, 0x10000
    ds_read_b64_tr_b16 v[32:33], v4 offset:16384
    ds_read_b64_tr_b16 v[34:35], v4 offset:16896
    ds_read_b128 v[48:51], v5 offset:16384
    ds_read_b64_tr_b16 v[36:37], v4 offset:18432
    ds_read_b64_tr_b16 v[38:39], v4 offset:18944
    ds_read_b128 v[52:55], v5 offset:18432
    ds_read_b64_tr_b16 v[40:41], v4 offset:20480
    ds_read_b64_tr_b16 v[42:43], v4 offset:20992
    ds_read_b128 v[56:59], v5 offset:20480
    ds_read_b64_tr_b16 v[44:45], v4 offset:22528
    ds_read_b64_tr_b16 v[46:47], v4 offset:23040
    ds_read_b128 v[60:63], v5 offset:22528
    s_waitcnt lgkmcnt(9)
    v_mfma_f32_32x32x16_bf16 v[16:31], v[32:35], v[48:51], v[16:31]
    s_waitcnt lgkmcnt(6)
    v_mfma_f32_32x32x16_bf16 v[16:31], v[36:39], v[52:55], v[16:31]
    s_waitcnt lgkmcnt(3)
    v_mfma_f32_32x32x16_bf16 v[16:31], v[40:43], v[56:59], v[16:31]
    s_waitcnt lgkmcnt(0)
    v_mfma_f32_32x32x16_bf16 v[16:31], v[44:47], v[60:63], v[16:31]
    s_waitcnt vmcnt(8)
    s_barrier
    s_add_u32 m0, s66, 16384
    s_nop 0
    buffer_load_dwordx4 v2, s[20:23], s62 offen lds
    s_add_u32 m0, s66, 17408
    s_nop 0
    buffer_load_dwordx4 v2, s[20:23], s63 offen lds
    s_add_u32 m0, s66, 24576
    s_nop 0
    buffer_load_dwordx4 v3, s[24:27], s64 offen lds
    s_add_u32 m0, s66, 25600
    s_nop 0
    buffer_load_dwordx4 v3, s[24:27], s65 offen lds
    s_add_u32 s62, s62, 262144
    s_add_u32 s63, s63, 262144
    s_add_u32 s64, s64, 0x10000
    s_add_u32 s65, s65, 0x10000
    ds_read_b64_tr_b16 v[32:33], v4 offset:32768
    ds_read_b64_tr_b16 v[34:35], v4 offset:33280
    ds_read_b128 v[48:51], v5 offset:32768
    ds_read_b64_tr_b16 v[36:37], v4 offset:34816
    ds_read_b64_tr_b16 v[38:39], v4 offset:35328
    ds_read_b128 v[52:55], v5 offset:34816
    ds_read_b64_tr_b16 v[40:41], v4 offset:36864
    ds_read_b64_tr_b16 v[42:43], v4 offset:37376
    ds_read_b128 v[56:59], v5 offset:36864
    ds_read_b64_tr_b16 v[44:45], v4 offset:38912
    ds_read_b64_tr_b16 v[46:47], v4 offset:39424
    ds_read_b128 v[60:63], v5 offset:38912
    s_waitcnt lgkmcnt(9)
    v_mfma_f32_32x32x16_bf16 v[16:31], v[32:35], v[48:51], v[16:31]
    s_waitcnt lgkmcnt(6)
    v_mfma_f32_32x32x16_bf16 v[16:31], v[36:39], v[52:55], v[16:31]
    s_waitcnt lgkmcnt(3)
    v_mfma_f32_32x32x16_bf16 v[16:31], v[40:43], v[56:59], v[16:31]
    s_waitcnt lgkmcnt(0)
    v_mfma_f32_32x32x16_bf16 v[16:31], v[44:47], v[60:63], v[16:31]
    s_waitcnt vmcnt(8)
    s_barrier
    s_add_u32 m0, s66, 32768
    s_nop 0
    buffer_load_dwordx4 v2, s[20:23], s62 offen lds
    s_add_u32 m0, s66, 33792
    s_nop 0
    buffer_load_dwordx4 v2, s[20:23], s63 offen lds
    s_add_u32 m0, s66, 40960
    s_nop 0
    buffer_load_dwordx4 v3, s[24:27], s64 offen lds
    s_add_u32 m0, s66, 41984
    s_nop 0
    buffer_load_dwordx4 v3, s[24:27], s65 offen lds
    s_add_u32 s62, s62, 262144
    s_add_u32 s63, s63, 262144
    s_add_u32 s64, s64, 0x10000
    s_add_u32 s65, s65, 0x10000
    ds_read_b64_tr_b16 v[32:33], v4 offset:49152
    ds_read_b64_tr_b16 v[34:35], v4 offset:49664
    ds_read_b128 v[48:51], v5 offset:49152
    ds_read_b64_tr_b16 v[36:37], v4 offset:51200
    ds_read_b64_tr_b16 v[38:39], v4 offset:51712
    ds_read_b128 v[52:55], v5 offset:51200
    ds_read_b64_tr_b16 v[40:41], v4 offset:53248
    ds_read_b64_tr_b16 v[42:43], v4 offset:53760
    ds_read_b128 v[56:59], v5 offset:53248
    ds_read_b64_tr_b16 v[44:45], v4 offset:55296
    ds_read_b64_tr_b16 v[46:47], v4 offset:55808
    ds_read_b128 v[60:63], v5 offset:55296
    s_waitcnt lgkmcnt(9)
    v_mfma_f32_32x32x16_bf16 v[16:31], v[32:35], v[48:51], v[16:31]
    s_waitcnt lgkmcnt(6)
    v_mfma_f32_32x32x16_bf16 v[16:31], v[36:39], v[52:55], v[16:31]
    s_waitcnt lgkmcnt(3)
    v_mfma_f32_32x32x16_bf16 v[16:31], v[40:43], v[56:59], v[16:31]
    s_waitcnt lgkmcnt(0)
    v_mfma_f32_32x32x16_bf16 v[16:31], v[44:47], v[60:63], v[16:31]
    s_waitcnt vmcnt(8)
    s_barrier
    s_add_u32 m0, s66, 49152
    s_nop 0
    buffer_load_dwordx4 v2, s[20:23], s62 offen lds
    s_add_u32 m0, s66, 50176
    s_nop 0
    buffer_load_dwordx4 v2, s[20:23], s63 offen lds
    s_add_u32 m0, s66, 57344
    s_nop 0
    buffer_load_dwordx4 v3, s[24:27], s64 offen lds
    s_add_u32 m0, s66, 58368
    s_nop 0
    buffer_load_dwordx4 v3, s[24:27], s65 offen lds
    s_add_u32 s62, s62, 262144
    s_add_u32 s63, s63, 262144
    s_add_u32 s64, s64, 0x10000
    s_add_u32 s65, s65, 0x10000
    ds_read_b64_tr_b16 v[32:33], v4 offset:0
    ds_read_b64_tr_b16 v[34:35], v4 offset:512
    ds_read_b128 v[48:51], v5 offset:0
    ds_read_b64_tr_b16 v[36:37], v4 offset:2048
    ds_read_b64_tr_b16 v[38:39], v4 offset:2560
    ds_read_b128 v[52:55], v5 offset:2048
    ds_read_b64_tr_b16 v[40:41], v4 offset:4096
    ds_read_b64_tr_b16 v[42:43], v4 offset:4608
    ds_read_b128 v[56:59], v5 offset:4096
    ds_read_b64_tr_b16 v[44:45], v4 offset:6144
    ds_read_b64_tr_b16 v[46:47], v4 offset:6656
    ds_read_b128 v[60:63], v5 offset:6144
    s_waitcnt lgkmcnt(9)
    v_mfma_f32_32x32x16_bf16 v[16:31], v[32:35], v[48:51], v[16:31]
    s_waitcnt lgkmcnt(6)
    v_mfma_f32_32x32x16_bf16 v[16:31], v[36:39], v[52:55], v[16:31]
    s_waitcnt lgkmcnt(3)
    v_mfma_f32_32x32x16_bf16 v[16:31], v[40:43], v[56:59], v[16:31]
    s_waitcnt lgkmcnt(0)
    v_mfma_f32_32x32x16_bf16 v[16:31], v[44:47], v[60:63], v[16:31]
    s_waitcnt vmcnt(8)
    s_barrier
    s_add_u32 m0, s66, 0
    s_nop 0
    buffer_load_dwordx4 v2, s[20:23], s62 offen lds
    s_add_u32 m0, s66, 1024
    s_nop 0
    buffer_load_dwordx4 v2, s[20:23], s63 offen lds
    s_add_u32 m0, s66, 8192
    s_nop 0
    buffer_load_dwordx4 v3, s[24:27], s64 offen lds
    s_add_u32 m0, s66, 9216
    s_nop 0
    buffer_load_dwordx4 v3, s[24:27], s65 offen lds
    s_add_u32 s62, s62, 262144
    s_add_u32 s63, s63, 262144
    s_add_u32 s64, s64, 0x10000
    s_add_u32 s65, s65, 0x10000
    ds_read_b64_tr_b16 v[32:33], v4 offset:16384
    ds_read_b64_tr_b16 v[34:35], v4 offset:16896
    ds_read_b128 v[48:51], v5 offset:16384
    ds_read_b64_tr_b16 v[36:37], v4 offset:18432
    ds_read_b64_tr_b16 v[38:39], v4 offset:18944
    ds_read_b128 v[52:55], v5 offset:18432
    ds_read_b64_tr_b16 v[40:41], v4 offset:20480
    ds_read_b64_tr_b16 v[42:43], v4 offset:20992
    ds_read_b128 v[56:59], v5 offset:20480
    ds_read_b64_tr_b16 v[44:45], v4 offset:22528
    ds_read_b64_tr_b16 v[46:47], v4 offset:23040
    ds_read_b128 v[60:63], v5 offset:22528
    s_waitcnt lgkmcnt(9)
    v_mfma_f32_32x32x16_bf16 v[16:31], v[32:35], v[48:51], v[16:31]
    s_waitcnt lgkmcnt(6)
    v_mfma_f32_32x32x16_bf16 v[16:31], v[36:39], v[52:55], v[16:31]
    s_waitcnt lgkmcnt(3)
    v_mfma_f32_32x32x16_bf16 v[16:31], v[40:43], v[56:59], v[16:31]
    s_waitcnt lgkmcnt(0)
    v_mfma_f32_32x32x16_bf16 v[16:31], v[44:47], v[60:63], v[16:31]
    s_waitcnt vmcnt(8)
    s_barrier
    s_add_u32 m0, s66, 16384
    s_nop 0
    buffer_load_dwordx4 v2, s[20:23], s62 offen lds
    s_add_u32 m0, s66, 17408
    s_nop 0
    buffer_load_dwordx4 v2, s[20:23], s63 offen lds
    s_add_u32 m0, s66, 24576
    s_nop 0
    buffer_load_dwordx4 v3, s[24:27], s64 offen lds
    s_add_u32 m0, s66, 25600
    s_nop 0
    buffer_load_dwordx4 v3, s[24:27], s65 offen lds
    s_add_u32 s62, s62, 262144
    s_add_u32 s63, s63, 262144
    s_add_u32 s64, s64, 0x10000
    s_add_u32 s65, s65, 0x10000
    ds_read_b64_tr_b16 v[32:33], v4 offset:32768
    ds_read_b64_tr_b16 v[34:35], v4 offset:33280
    ds_read_b128 v[48:51], v5 offset:32768
    ds_read_b64_tr_b16 v[36:37], v4 offset:34816
    ds_read_b64_tr_b16 v[38:39], v4 offset:35328
    ds_read_b128 v[52:55], v5 offset:34816
    ds_read_b64_tr_b16 v[40:41], v4 offset:36864
    ds_read_b64_tr_b16 v[42:43], v4 offset:37376
    ds_read_b128 v[56:59], v5 offset:36864
    ds_read_b64_tr_b16 v[44:45], v4 offset:38912
    ds_read_b64_tr_b16 v[46:47], v4 offset:39424
    ds_read_b128 v[60:63], v5 offset:38912
    s_waitcnt lgkmcnt(9)
    v_mfma_f32_32x32x16_bf16 v[16:31], v[32:35], v[48:51], v[16:31]
    s_waitcnt lgkmcnt(6)
    v_mfma_f32_32x32x16_bf16 v[16:31], v[36:39], v[52:55], v[16:31]
    s_waitcnt lgkmcnt(3)
    v_mfma_f32_32x32x16_bf16 v[16:31], v[40:43], v[56:59], v[16:31]
    s_waitcnt lgkmcnt(0)
    v_mfma_f32_32x32x16_bf16 v[16:31], v[44:47], v[60:63], v[16:31]
    s_waitcnt vmcnt(8)
    s_barrier
    s_add_u32 m0, s66, 32768
    s_nop 0
    buffer_load_dwordx4 v2, s[20:23], s62 offen lds
    s_add_u32 m0, s66, 33792
    s_nop 0
    buffer_load_dwordx4 v2, s[20:23], s63 offen lds
    s_add_u32 m0, s66, 40960
    s_nop 0
    buffer_load_dwordx4 v3, s[24:27], s64 offen lds
    s_add_u32 m0, s66, 41984
    s_nop 0
    buffer_load_dwordx4 v3, s[24:27], s65 offen lds
    s_add_u32 s62, s62, 262144
    s_add_u32 s63, s63, 262144
    s_add_u32 s64, s64, 0x10000
    s_add_u32 s65, s65, 0x10000
    ds_read_b64_tr_b16 v[32:33], v4 offset:49152
    ds_read_b64_tr_b16 v[34:35], v4 offset:49664
    ds_read_b128 v[48:51], v5 offset:49152
    ds_read_b64_tr_b16 v[36:37], v4 offset:51200
    ds_read_b64_tr_b16 v[38:39], v4 offset:51712
    ds_read_b128 v[52:55], v5 offset:51200
    ds_read_b64_tr_b16 v[40:41], v4 offset:53248
    ds_read_b64_tr_b16 v[42:43], v4 offset:53760
    ds_read_b128 v[56:59], v5 offset:53248
    ds_read_b64_tr_b16 v[44:45], v4 offset:55296
    ds_read_b64_tr_b16 v[46:47], v4 offset:55808
    ds_read_b128 v[60:63], v5 offset:55296
    s_waitcnt lgkmcnt(9)
    v_mfma_f32_32x32x16_bf16 v[16:31], v[32:35], v[48:51], v[16:31]
    s_waitcnt lgkmcnt(6)
    v_mfma_f32_32x32x16_bf16 v[16:31], v[36:39], v[52:55], v[16:31]
    s_waitcnt lgkmcnt(3)
    v_mfma_f32_32x32x16_bf16 v[16:31], v[40:43], v[56:59], v[16:31]
    s_waitcnt lgkmcnt(0)
    v_mfma_f32_32x32x16_bf16 v[16:31], v[44:47], v[60:63], v[16:31]
    s_waitcnt vmcnt(8)
    s_barrier
    s_add_u32 m0, s66, 49152
    s_nop 0
    buffer_load_dwordx4 v2, s[20:23], s62 offen lds
    s_add_u32 m0, s66, 50176
    s_nop 0
    buffer_load_dwordx4 v2, s[20:23], s63 offen lds
    s_add_u32 m0, s66, 57344
    s_nop 0
    buffer_load_dwordx4 v3, s[24:27], s64 offen lds
    s_add_u32 m0, s66, 58368
    s_nop 0
    buffer_load_dwordx4 v3, s[24:27], s65 offen lds
    s_add_u32 s62, s62, 262144
    s_add_u32 s63, s63, 262144
    s_add_u32 s64, s64, 0x10000
    s_add_u32 s65, s65, 0x10000
    ds_read_b64_tr_b16 v[32:33], v4 offset:0
    ds_read_b64_tr_b16 v[34:35], v4 offset:512
    ds_read_b128 v[48:51], v5 offset:0
    ds_read_b64_tr_b16 v[36:37], v4 offset:2048
    ds_read_b64_tr_b16 v[38:39], v4 offset:2560
    ds_read_b128 v[52:55], v5 offset:2048
    ds_read_b64_tr_b16 v[40:41], v4 offset:4096
    ds_read_b64_tr_b16 v[42:43], v4 offset:4608
    ds_read_b128 v[56:59], v5 offset:4096
    ds_read_b64_tr_b16 v[44:45], v4 offset:6144
    ds_read_b64_tr_b16 v[46:47], v4 offset:6656
    ds_read_b128 v[60:63], v5 offset:6144
    s_waitcnt lgkmcnt(9)
    v_mfma_f32_32x32x16_bf16 v[16:31], v[32:35], v[48:51], v[16:31]
    s_waitcnt lgkmcnt(6)
    v_mfma_f32_32x32x16_bf16 v[16:31], v[36:39], v[52:55], v[16:31]
    s_waitcnt lgkmcnt(3)
    v_mfma_f32_32x32x16_bf16 v[16:31], v[40:43], v[56:59], v[16:31]
    s_waitcnt lgkmcnt(0)
    v_mfma_f32_32x32x16_bf16 v[16:31], v[44:47], v[60:63], v[16:31]
    s_waitcnt vmcnt(8)
    s_barrier
    ds_read_b64_tr_b16 v[32:33], v4 offset:16384
    ds_read_b64_tr_b16 v[34:35], v4 offset:16896
    ds_read_b128 v[48:51], v5 offset:16384
    ds_read_b64_tr_b16 v[36:37], v4 offset:18432
    ds_read_b64_tr_b16 v[38:39], v4 offset:18944
    ds_read_b128 v[52:55], v5 offset:18432
    ds_read_b64_tr_b16 v[40:41], v4 offset:20480
    ds_read_b64_tr_b16 v[42:43], v4 offset:20992
    ds_read_b128 v[56:59], v5 offset:20480
    ds_read_b64_tr_b16 v[44:45], v4 offset:22528
    ds_read_b64_tr_b16 v[46:47], v4 offset:23040
    ds_read_b128 v[60:63], v5 offset:22528
    s_waitcnt lgkmcnt(9)
    v_mfma_f32_32x32x16_bf16 v[16:31], v[32:35], v[48:51], v[16:31]
    s_waitcnt lgkmcnt(6)
    v_mfma_f32_32x32x16_bf16 v[16:31], v[36:39], v[52:55], v[16:31]
    s_waitcnt lgkmcnt(3)
    v_mfma_f32_32x32x16_bf16 v[16:31], v[40:43], v[56:59], v[16:31]
    s_waitcnt lgkmcnt(0)
    v_mfma_f32_32x32x16_bf16 v[16:31], v[44:47], v[60:63], v[16:31]
    s_waitcnt vmcnt(4)
    s_barrier
    ds_read_b64_tr_b16 v[32:33], v4 offset:32768
    ds_read_b64_tr_b16 v[34:35], v4 offset:33280
    ds_read_b128 v[48:51], v5 offset:32768
    ds_read_b64_tr_b16 v[36:37], v4 offset:34816
    ds_read_b64_tr_b16 v[38:39], v4 offset:35328
    ds_read_b128 v[52:55], v5 offset:34816
    ds_read_b64_tr_b16 v[40:41], v4 offset:36864
    ds_read_b64_tr_b16 v[42:43], v4 offset:37376
    ds_read_b128 v[56:59], v5 offset:36864
    ds_read_b64_tr_b16 v[44:45], v4 offset:38912
    ds_read_b64_tr_b16 v[46:47], v4 offset:39424
    ds_read_b128 v[60:63], v5 offset:38912
    s_waitcnt lgkmcnt(9)
    v_mfma_f32_32x32x16_bf16 v[16:31], v[32:35], v[48:51], v[16:31]
    s_waitcnt lgkmcnt(6)
    v_mfma_f32_32x32x16_bf16 v[16:31], v[36:39], v[52:55], v[16:31]
    s_waitcnt lgkmcnt(3)
    v_mfma_f32_32x32x16_bf16 v[16:31], v[40:43], v[56:59], v[16:31]
    s_waitcnt lgkmcnt(0)
    v_mfma_f32_32x32x16_bf16 v[16:31], v[44:47], v[60:63], v[16:31]
    s_waitcnt vmcnt(0)
    s_barrier
    ds_read_b64_tr_b16 v[32:33], v4 offset:49152
    ds_read_b64_tr_b16 v[34:35], v4 offset:49664
    ds_read_b128 v[48:51], v5 offset:49152
    ds_read_b64_tr_b16 v[36:37], v4 offset:51200
    ds_read_b64_tr_b16 v[38:39], v4 offset:51712
    ds_read_b128 v[52:55], v5 offset:51200
    ds_read_b64_tr_b16 v[40:41], v4 offset:53248
    ds_read_b64_tr_b16 v[42:43], v4 offset:53760
    ds_read_b128 v[56:59], v5 offset:53248
    ds_read_b64_tr_b16 v[44:45], v4 offset:55296
    ds_read_b64_tr_b16 v[46:47], v4 offset:55808
    ds_read_b128 v[60:63], v5 offset:55296
    s_waitcnt lgkmcnt(9)
    v_mfma_f32_32x32x16_bf16 v[16:31], v[32:35], v[48:51], v[16:31]
    s_waitcnt lgkmcnt(6)
    v_mfma_f32_32x32x16_bf16 v[16:31], v[36:39], v[52:55], v[16:31]
    s_waitcnt lgkmcnt(3)
    v_mfma_f32_32x32x16_bf16 v[16:31], v[40:43], v[56:59], v[16:31]
    s_waitcnt lgkmcnt(0)
    v_mfma_f32_32x32x16_bf16 v[16:31], v[44:47], v[60:63], v[16:31]
    v_lshrrev_b32 v6, 5, v0
    v_lshlrev_b32 v6, 12, v6
    v_lshlrev_b32 v8, 1, v7
    v_add_u32 v6, v6, v8
    s_lshl_b32 s67, s14, 16
    s_lshl_b32 s70, s60, 15
    s_add_u32 s67, s67, s70
    s_nop 4
    v_cvt_pk_bf16_f32 v8, v16, v17
    v_lshlrev_b32 v9, 16, v8
    v_and_b32 v10, 0xffff0000, v8
    v_lshlrev_b32 v11, 16, v64
    v_and_b32 v12, 0xffff0000, v64
    v_add_f32 v9, v9, v11
    v_add_f32 v10, v10, v12
    v_cvt_pk_bf16_f32 v8, v9, v10
    v_lshlrev_b32 v9, 16, v8
    v_and_b32 v10, 0xffff0000, v8
    v_lshlrev_b32 v11, 16, v72
    v_and_b32 v12, 0xffff0000, v72
    v_add_f32 v9, v11, v9
    v_add_f32 v10, v12, v10
    v_cvt_pk_bf16_f32 v80, v9, v10
    v_cvt_pk_bf16_f32 v8, v18, v19
    v_lshlrev_b32 v9, 16, v8
    v_and_b32 v10, 0xffff0000, v8
    v_lshlrev_b32 v11, 16, v65
    v_and_b32 v12, 0xffff0000, v65
    v_add_f32 v9, v9, v11
    v_add_f32 v10, v10, v12
    v_cvt_pk_bf16_f32 v8, v9, v10
    v_lshlrev_b32 v9, 16, v8
    v_and_b32 v10, 0xffff0000, v8
    v_lshlrev_b32 v11, 16, v73
    v_and_b32 v12, 0xffff0000, v73
    v_add_f32 v9, v11, v9
    v_add_f32 v10, v12, v10
    v_cvt_pk_bf16_f32 v81, v9, v10
    s_add_u32 s71, s67, 0
    buffer_store_short v80, v6, s[36:39], s71 offen
    buffer_store_short_d16_hi v80, v6, s[36:39], s71 offen offset:1024
    s_add_u32 s71, s67, 2048
    buffer_store_short v81, v6, s[36:39], s71 offen
    buffer_store_short_d16_hi v81, v6, s[36:39], s71 offen offset:1024
    v_cvt_pk_bf16_f32 v8, v20, v21
    v_lshlrev_b32 v9, 16, v8
    v_and_b32 v10, 0xffff0000, v8
    v_lshlrev_b32 v11, 16, v66
    v_and_b32 v12, 0xffff0000, v66
    v_add_f32 v9, v9, v11
    v_add_f32 v10, v10, v12
    v_cvt_pk_bf16_f32 v8, v9, v10
    v_lshlrev_b32 v9, 16, v8
    v_and_b32 v10, 0xffff0000, v8
    v_lshlrev_b32 v11, 16, v74
    v_and_b32 v12, 0xffff0000, v74
    v_add_f32 v9, v11, v9
    v_add_f32 v10, v12, v10
    v_cvt_pk_bf16_f32 v80, v9, v10
    v_cvt_pk_bf16_f32 v8, v22, v23
    v_lshlrev_b32 v9, 16, v8
    v_and_b32 v10, 0xffff0000, v8
    v_lshlrev_b32 v11, 16, v67
    v_and_b32 v12, 0xffff0000, v67
    v_add_f32 v9, v9, v11
    v_add_f32 v10, v10, v12
    v_cvt_pk_bf16_f32 v8, v9, v10
    v_lshlrev_b32 v9, 16, v8
    v_and_b32 v10, 0xffff0000, v8
    v_lshlrev_b32 v11, 16, v75
    v_and_b32 v12, 0xffff0000, v75
    v_add_f32 v9, v11, v9
    v_add_f32 v10, v12, v10
    v_cvt_pk_bf16_f32 v81, v9, v10
    s_add_u32 s71, s67, 8192
    buffer_store_short v80, v6, s[36:39], s71 offen
    buffer_store_short_d16_hi v80, v6, s[36:39], s71 offen offset:1024
    s_add_u32 s71, s67, 10240
    buffer_store_short v81, v6, s[36:39], s71 offen
    buffer_store_short_d16_hi v81, v6, s[36:39], s71 offen offset:1024
    v_cvt_pk_bf16_f32 v8, v24, v25
    v_lshlrev_b32 v9, 16, v8
    v_and_b32 v10, 0xffff0000, v8
    v_lshlrev_b32 v11, 16, v68
    v_and_b32 v12, 0xffff0000, v68
    v_add_f32 v9, v9, v11
    v_add_f32 v10, v10, v12
    v_cvt_pk_bf16_f32 v8, v9, v10
    v_lshlrev_b32 v9, 16, v8
    v_and_b32 v10, 0xffff0000, v8
    v_lshlrev_b32 v11, 16, v76
    v_and_b32 v12, 0xffff0000, v76
    v_add_f32 v9, v11, v9
    v_add_f32 v10, v12, v10
    v_cvt_pk_bf16_f32 v80, v9, v10
    v_cvt_pk_bf16_f32 v8, v26, v27
    v_lshlrev_b32 v9, 16, v8
    v_and_b32 v10, 0xffff0000, v8
    v_lshlrev_b32 v11, 16, v69
    v_and_b32 v12, 0xffff0000, v69
    v_add_f32 v9, v9, v11
    v_add_f32 v10, v10, v12
    v_cvt_pk_bf16_f32 v8, v9, v10
    v_lshlrev_b32 v9, 16, v8
    v_and_b32 v10, 0xffff0000, v8
    v_lshlrev_b32 v11, 16, v77
    v_and_b32 v12, 0xffff0000, v77
    v_add_f32 v9, v11, v9
    v_add_f32 v10, v12, v10
    v_cvt_pk_bf16_f32 v81, v9, v10
    s_add_u32 s71, s67, 16384
    buffer_store_short v80, v6, s[36:39], s71 offen
    buffer_store_short_d16_hi v80, v6, s[36:39], s71 offen offset:1024
    s_add_u32 s71, s67, 18432
    buffer_store_short v81, v6, s[36:39], s71 offen
    buffer_store_short_d16_hi v81, v6, s[36:39], s71 offen offset:1024
    v_cvt_pk_bf16_f32 v8, v28, v29
    v_lshlrev_b32 v9, 16, v8
    v_and_b32 v10, 0xffff0000, v8
    v_lshlrev_b32 v11, 16, v70
    v_and_b32 v12, 0xffff0000, v70
    v_add_f32 v9, v9, v11
    v_add_f32 v10, v10, v12
    v_cvt_pk_bf16_f32 v8, v9, v10
    v_lshlrev_b32 v9, 16, v8
    v_and_b32 v10, 0xffff0000, v8
    v_lshlrev_b32 v11, 16, v78
    v_and_b32 v12, 0xffff0000, v78
    v_add_f32 v9, v11, v9
    v_add_f32 v10, v12, v10
    v_cvt_pk_bf16_f32 v80, v9, v10
    v_cvt_pk_bf16_f32 v8, v30, v31
    v_lshlrev_b32 v9, 16, v8
    v_and_b32 v10, 0xffff0000, v8
    v_lshlrev_b32 v11, 16, v71
    v_and_b32 v12, 0xffff0000, v71
    v_add_f32 v9, v9, v11
    v_add_f32 v10, v10, v12
    v_cvt_pk_bf16_f32 v8, v9, v10
    v_lshlrev_b32 v9, 16, v8
    v_and_b32 v10, 0xffff0000, v8
    v_lshlrev_b32 v11, 16, v79
    v_and_b32 v12, 0xffff0000, v79
    v_add_f32 v9, v11, v9
    v_add_f32 v10, v12, v10
    v_cvt_pk_bf16_f32 v81, v9, v10
    s_add_u32 s71, s67, 24576
    buffer_store_short v80, v6, s[36:39], s71 offen
    buffer_store_short_d16_hi v80, v6, s[36:39], s71 offen offset:1024
    s_add_u32 s71, s67, 26624
    buffer_store_short v81, v6, s[36:39], s71 offen
    buffer_store_short_d16_hi v81, v6, s[36:39], s71 offen offset:1024
    s_endpgm
k2_end:
    s_endpgm
.section .rodata,"a"
.p2align 6
.amdhsa_kernel k0_kernel
  .amdhsa_next_free_vgpr 104
  .amdhsa_next_free_sgpr 96
  .amdhsa_accum_offset 104
  .amdhsa_group_segment_fixed_size 0
  .amdhsa_kernarg_size 120
  .amdhsa_user_sgpr_count 2
  .amdhsa_user_sgpr_kernarg_segment_ptr 1
  .amdhsa_system_sgpr_workgroup_id_x 1
.end_amdhsa_kernel
.amdhsa_kernel k1_kernel
  .amdhsa_next_free_vgpr 168
  .amdhsa_next_free_sgpr 96
  .amdhsa_accum_offset 168
  .amdhsa_group_segment_fixed_size 0
  .amdhsa_kernarg_size 120
  .amdhsa_user_sgpr_count 2
  .amdhsa_user_sgpr_kernarg_segment_ptr 1
  .amdhsa_system_sgpr_workgroup_id_x 1
.end_amdhsa_kernel
.amdhsa_kernel k2_kernel
  .amdhsa_next_free_vgpr 96
  .amdhsa_next_free_sgpr 96
  .amdhsa_accum_offset 96
  .amdhsa_group_segment_fixed_size 0
  .amdhsa_kernarg_size 120
  .amdhsa_user_sgpr_count 2
  .amdhsa_user_sgpr_kernarg_segment_ptr 1
  .amdhsa_system_sgpr_workgroup_id_x 1
.end_amdhsa_kernel
```
